```python
import torch

def _softmax(x, axis=-1):
    return torch.softmax(x, dim=axis)
def _gelu(x):
    return torch.nn.functional.gelu(x, approximate="tanh")
def _silu(x):
    return torch.nn.functional.silu(x)
def _sigmoid(x):
    return torch.sigmoid(x)
def _layernorm(x, axis=-1, eps=1e-5):
    m = x.mean(dim=axis, keepdim=True)
    v = x.var(dim=axis, keepdim=True, unbiased=False)
    return (x - m) / torch.sqrt(v + eps)
def _scatter_add(tgt, idx, src, axis=0):
    return tgt.clone().index_add_(axis, idx, src)
def _segment_sum(src, seg, n):
    out = torch.zeros((n,) + src.shape[1:], dtype=src.dtype)
    return out.index_add_(0, seg, src)
def _pad(x, pw):
    flat = tuple(v for pair in reversed(pw) for v in pair)
    return torch.nn.functional.pad(x, flat)

kernel_name = 'standalone__edge_featured_mpnn_gatedgcn__graph'

def setup_inputs():

    _w = (lambda a: (lambda t: t.to(torch.bfloat16) if t.is_floating_point() else t)(torch.as_tensor(a)))
    N, deg, D, De = 12500, 32, 128, max(16, 1)
    E = N * deg
    return {
        "x": _w((lambda *s: torch.randn(*s, dtype=torch.bfloat16) * 0.4)(N, D)),
        "e_attr": _w((lambda *s: torch.randn(*s, dtype=torch.bfloat16) * 0.8)(E, De)),
        "src": _w((lambda lo, hi, *s: torch.randint(lo, hi, s))(0, N, E).to(torch.int64)),
        "dst": _w((lambda lo, hi, *s: torch.randint(lo, hi, s))(0, N, E).to(torch.int64)),
        "w_a": _w((lambda *s: torch.randn(*s, dtype=torch.bfloat16) * 0.4)(D, D)),
        "w_b": _w((lambda *s: torch.randn(*s, dtype=torch.bfloat16) * 0.4)(D, D)),
        "w_c": _w((lambda *s: torch.randn(*s, dtype=torch.bfloat16) * 0.8)(De, D)),
        "w_u": _w((lambda *s: torch.randn(*s, dtype=torch.bfloat16) * 0.05)(D, D)),
        "w_v": _w((lambda *s: torch.randn(*s, dtype=torch.bfloat16) * 0.05)(D, D)),
    }

def reference(x, e_attr, src, dst, w_a, w_b, w_c, w_u, w_v):
    N, D = x.shape
    hv = x @ w_v
    g = x[dst] @ w_a + x[src] @ w_b + e_attr @ w_c
    eta = _sigmoid(g)
    denom = _segment_sum(eta, dst, N) + 1e-6
    eta_n = eta / denom[dst]
    agg = _segment_sum(eta_n * hv[src], dst, N)
    z = x @ w_u + agg
    relu_z = torch.where(z > 0, z, 0 * z)
    return x + relu_z
```

```asm
; @launch grid=(256,1,1) block=(768,1,1) lds=163840
.amdgcn_target "amdgcn-amd-amdhsa--gfx950"
.text
.globl standalone__edge_featured_mpnn_gatedgcn__graph_kernel
.p2align 8
.type standalone__edge_featured_mpnn_gatedgcn__graph_kernel,@function
standalone__edge_featured_mpnn_gatedgcn__graph_kernel:
    s_cmp_ge_u32 s2, 256
    s_cbranch_scc1 F_END
    s_load_dwordx2 s[44:45], s[0:1], 24
    s_load_dwordx2 s[40:41], s[0:1], 16
    s_load_dwordx2 s[8:9], s[0:1], 0
    s_load_dwordx2 s[32:33], s[0:1], 40
    s_load_dwordx2 s[36:37], s[0:1], 64
    s_load_dwordx2 s[92:93], s[0:1], 32
    s_load_dwordx2 s[94:95], s[0:1], 56
    s_load_dwordx2 s[28:29], s[0:1], 48
    s_load_dwordx2 s[16:17], s[0:1], 88
    v_lshrrev_b32 v2, 6, v0
    v_and_b32 v1, 63, v0
    v_readfirstlane_b32 s3, v2
    s_mov_b32 s56, s2
    s_lshr_b32 s57, s2, 3
    s_and_b32 s2, s2, 7
    s_lshl_b32 s2, s2, 5
    s_or_b32 s2, s2, s57
    s_mov_b32 s46, 0x186a00
    s_mov_b32 s47, 0x20000
    s_mov_b32 s42, 0x186a00
    s_mov_b32 s43, 0x20000
    s_mov_b32 s10, 0x30d400
    s_mov_b32 s11, 0x20000
    s_mov_b32 s34, 0x8000
    s_mov_b32 s35, 0x20000
    s_mov_b32 s38, 0x8000
    s_mov_b32 s39, 0x20000
    s_mov_b32 s30, 0x1000
    s_mov_b32 s31, 0x20000
    s_mov_b32 s18, 0x8ca000
    s_mov_b32 s19, 0x20000
    s_and_b32 s52, s3, 3
    v_lshrrev_b32 v4, 4, v1
    v_lshlrev_b32 v5, 2, v4
    v_and_b32 v6, 15, v1
    v_xor_b32 v5, v5, v6
    v_lshlrev_b32 v5, 4, v5
    v_lshl_add_u32 v2, v4, 8, v5
    v_mov_b32 v7, 0
    v_mov_b32 v32, 0
    s_lshl_b32 s76, s56, 4
    s_add_u32 s76, s76, s3
    s_cmp_lg_u32 s76, 8
    s_cbranch_scc1 NOCLR
    v_lshrrev_b32 v12, 2, v1
    v_and_b32 v13, 3, v1
    v_lshlrev_b32 v13, 4, v13
    v_lshl_add_u32 v12, v12, 7, v13
    v_add_u32 v12, 0x7b0000, v12
    v_mov_b64 v[8:9], 0
    v_mov_b64 v[10:11], 0
    s_mov_b32 s76, 8
    s_waitcnt lgkmcnt(0)
CLR:
    buffer_store_dwordx4 v[8:11], v12, s[16:19], 0 offen sc1
    buffer_store_dwordx4 v[8:11], v12, s[16:19], 0 offen offset:2048 sc1
    v_add_u32 v12, 4096, v12
    s_sub_u32 s76, s76, 1
    s_cmp_lg_u32 s76, 0
    s_cbranch_scc1 CLR
NOCLR:
    s_cmp_lg_u32 s3, 0
    s_cbranch_scc1 NOCPF
    s_getpc_b64 s[76:77]
PCREF:
    s_lshl_b32 s78, s57, 7
    v_lshl_add_u32 v160, v1, 12, s78
    v_min_u32 v160, CODE_END-PCREF-4, v160
    v_mov_b32 v161, 0
    v_lshl_add_u64 v[160:161], v[160:161], 0, s[76:77]
    s_mov_b64 exec, 31
    global_load_dword v162, v[160:161], off
    s_mov_b64 exec, -1
NOCPF:
    s_cmp_lt_u32 s56, 125
    s_cbranch_scc1 SORT
    s_sub_u32 s85, s56, 125
    s_cmp_lt_u32 s3, 4
    s_cbranch_scc1 G_XLD
    s_sub_u32 s79, s3, 4
    s_lshl_b32 s79, s79, 12
    s_waitcnt lgkmcnt(0)
    s_add_u32 m0, s79, 8192
    s_nop 0
    buffer_load_dwordx4 v2, s[32:35], s79 offen offset:0 lds
    buffer_load_dwordx4 v2, s[32:35], s79 offen offset:1024 lds
    buffer_load_dwordx4 v2, s[32:35], s79 offen offset:2048 lds
    buffer_load_dwordx4 v2, s[32:35], s79 offen offset:3072 lds
    s_add_u32 m0, s79, 40960
    s_nop 0
    buffer_load_dwordx4 v2, s[36:39], s79 offen offset:0 lds
    buffer_load_dwordx4 v2, s[36:39], s79 offen offset:1024 lds
    buffer_load_dwordx4 v2, s[36:39], s79 offen offset:2048 lds
    buffer_load_dwordx4 v2, s[36:39], s79 offen offset:3072 lds
    s_mov_b64 s[20:21], s[16:17]
    s_load_dwordx2 s[12:13], s[0:1], 8
    s_load_dwordx2 s[24:25], s[0:1], 72
    s_load_dwordx2 s[48:49], s[0:1], 80
    s_mov_b32 s22, 0xc62a800
    s_mov_b32 s23, 0x20000
    s_mov_b32 s14, 0xc35000
    s_mov_b32 s15, 0x20000
    s_mov_b32 s26, 0x30d400
    s_mov_b32 s27, 0x20000
    s_mov_b32 s50, 0x100
    s_mov_b32 s51, 0x20000
    s_mov_b32 s54, 0
    s_mov_b32 s55, 0
    s_bfe_u32 s53, s3, 0x10002
    s_branch G_LDD
G_XLD:
    s_lshl_b32 s77, s52, 2
    v_xor_b32 v5, v6, v4
    v_xor_b32 v5, s77, v5
    v_lshlrev_b32 v5, 4, v5
    v_lshl_add_u32 v20, v4, 8, v5
    s_mul_i32 s76, s85, 24576
    s_lshl_b32 s77, s52, 10
    s_add_u32 s76, s76, s77
    s_add_u32 s77, s77, 139264
    s_waitcnt lgkmcnt(0)
    s_add_u32 m0, s77, 0
    s_add_u32 s78, s76, 0
    buffer_load_dwordx4 v20, s[8:11], s78 offen  lds
    s_add_u32 m0, s77, 4096
    s_add_u32 s78, s76, 4096
    buffer_load_dwordx4 v20, s[8:11], s78 offen  lds
    s_add_u32 m0, s77, 8192
    s_add_u32 s78, s76, 8192
    buffer_load_dwordx4 v20, s[8:11], s78 offen  lds
    s_add_u32 m0, s77, 12288
    s_add_u32 s78, s76, 12288
    buffer_load_dwordx4 v20, s[8:11], s78 offen  lds
    s_add_u32 m0, s77, 16384
    s_add_u32 s78, s76, 16384
    buffer_load_dwordx4 v20, s[8:11], s78 offen  lds
    s_add_u32 m0, s77, 20480
    s_add_u32 s78, s76, 20480
    buffer_load_dwordx4 v20, s[8:11], s78 offen  lds
    s_mov_b64 s[20:21], s[16:17]
    s_load_dwordx2 s[12:13], s[0:1], 8
    s_load_dwordx2 s[24:25], s[0:1], 72
    s_load_dwordx2 s[48:49], s[0:1], 80
    s_mov_b32 s22, 0xc62a800
    s_mov_b32 s23, 0x20000
    s_mov_b32 s14, 0xc35000
    s_mov_b32 s15, 0x20000
    s_mov_b32 s26, 0x30d400
    s_mov_b32 s27, 0x20000
    s_mov_b32 s50, 0x100
    s_mov_b32 s51, 0x20000
    s_mov_b32 s54, 0
    s_mov_b32 s55, 0
    s_bfe_u32 s53, s3, 0x10002
G_LDD:
    s_cmp_ge_u32 s3, 8
    s_cbranch_scc1 G_NWC
    v_and_b32 v164, 31, v0
    v_bfe_u32 v165, v0, 5, 1
    s_lshl_b32 s86, s52, 6
    v_lshl_add_u32 v166, v164, 1, s86
    v_lshl_add_u32 v166, v165, 11, v166
    buffer_load_ushort v152, v166, s[28:31], 0 offen offset:0
    buffer_load_ushort v153, v166, s[28:31], 0 offen offset:256
    buffer_load_ushort v154, v166, s[28:31], 0 offen offset:512
    buffer_load_ushort v155, v166, s[28:31], 0 offen offset:768
    buffer_load_ushort v156, v166, s[28:31], 0 offen offset:1024
    buffer_load_ushort v157, v166, s[28:31], 0 offen offset:1280
    buffer_load_ushort v158, v166, s[28:31], 0 offen offset:1536
    buffer_load_ushort v159, v166, s[28:31], 0 offen offset:1792
G_NWC:
    s_lshr_b32 s80, s3, 2
    s_lshl_b32 s81, s80, 13
    s_add_u32 s81, s81, 139264
    v_lshrrev_b32 v5, 5, v1
    v_bfe_u32 v4, v1, 2, 2
    v_lshl_add_u32 v36, v5, 3, v4
    v_lshlrev_b32 v36, 8, v36
    v_xor_b32 v4, s52, v4
    v_lshl_add_u32 v36, v4, 6, v36
    v_bfe_u32 v4, v1, 4, 1
    v_lshl_add_u32 v36, v4, 5, v36
    v_and_b32 v4, 3, v1
    v_lshl_add_u32 v36, v4, 3, v36
    v_add_u32 v36, 8192, v36
    v_and_b32 v4, 15, v1
    v_xor_b32 v4, v4, v5
    v_lshlrev_b32 v4, 4, v4
    v_and_b32 v6, 31, v1
    v_lshl_add_u32 v4, v6, 8, v4
    v_add_u32 v8, s81, v4
    v_xor_b32 v9, 32, v8
    v_xor_b32 v10, 64, v8
    v_xor_b32 v11, 96, v8
    v_xor_b32 v12, 128, v8
    v_xor_b32 v13, 160, v8
    v_xor_b32 v14, 192, v8
    v_xor_b32 v15, 224, v8
    s_mul_i32 s81, s85, 49152
    s_lshl_b32 s82, s80, 14
    s_add_u32 s81, s81, s82
    s_lshl_b32 s82, s52, 7
    s_add_u32 s81, s81, s82
    s_add_u32 s81, s81, 0xc010000
    v_lshlrev_b32 v20, 2, v6
    v_lshl_add_u32 v20, v5, 11, v20
    v_add_u32 v20, s81, v20
    v_add_u32 v21, 4096, v20
    v_add_u32 v22, 8192, v20
    v_add_u32 v23, 12288, v20
    s_mov_b32 s58, 0
    s_waitcnt vmcnt(0) lgkmcnt(0)
    s_mov_b64 s[32:33], s[92:93]
    s_mov_b64 s[36:37], s[94:95]
    s_barrier
    s_cmp_lt_u32 s3, 8
    s_cbranch_scc1 CORE
    s_lshl_b32 s79, s52, 13
    s_add_u32 m0, s79, 73728
    s_nop 0
    buffer_load_dwordx4 v2, s[32:35], s79 offen offset:0 lds
    buffer_load_dwordx4 v2, s[32:35], s79 offen offset:1024 lds
    buffer_load_dwordx4 v2, s[32:35], s79 offen offset:2048 lds
    buffer_load_dwordx4 v2, s[32:35], s79 offen offset:3072 lds
    s_add_u32 m0, s79, 106496
    s_nop 0
    buffer_load_dwordx4 v2, s[36:39], s79 offen offset:0 lds
    buffer_load_dwordx4 v2, s[36:39], s79 offen offset:1024 lds
    buffer_load_dwordx4 v2, s[36:39], s79 offen offset:2048 lds
    buffer_load_dwordx4 v2, s[36:39], s79 offen offset:3072 lds
    s_add_u32 s79, s79, 4096
    s_add_u32 m0, s79, 73728
    s_nop 0
    buffer_load_dwordx4 v2, s[32:35], s79 offen offset:0 lds
    buffer_load_dwordx4 v2, s[32:35], s79 offen offset:1024 lds
    buffer_load_dwordx4 v2, s[32:35], s79 offen offset:2048 lds
    buffer_load_dwordx4 v2, s[32:35], s79 offen offset:3072 lds
    s_add_u32 m0, s79, 106496
    s_nop 0
    buffer_load_dwordx4 v2, s[36:39], s79 offen offset:0 lds
    buffer_load_dwordx4 v2, s[36:39], s79 offen offset:1024 lds
    buffer_load_dwordx4 v2, s[36:39], s79 offen offset:2048 lds
    buffer_load_dwordx4 v2, s[36:39], s79 offen offset:3072 lds
CORE:
    ds_read_b128 v[48:51], v8
    ds_read_b64_tr_b16 v[52:53], v36 offset:0
    ds_read_b64_tr_b16 v[54:55], v36 offset:1024
    ds_read_b64_tr_b16 v[56:57], v36 offset:32768
    ds_read_b64_tr_b16 v[58:59], v36 offset:33792
    ds_read_b128 v[60:63], v9
    ds_read_b64_tr_b16 v[64:65], v36 offset:4096
    ds_read_b64_tr_b16 v[66:67], v36 offset:5120
    ds_read_b64_tr_b16 v[68:69], v36 offset:36864
    ds_read_b64_tr_b16 v[70:71], v36 offset:37888
    ds_read_b128 v[72:75], v10
    ds_read_b64_tr_b16 v[76:77], v36 offset:8192
    ds_read_b64_tr_b16 v[78:79], v36 offset:9216
    ds_read_b64_tr_b16 v[80:81], v36 offset:40960
    ds_read_b64_tr_b16 v[82:83], v36 offset:41984
    s_waitcnt lgkmcnt(10)
    v_mfma_f32_32x32x16_bf16 v[100:115], v[48:51], v[56:59], 0
    v_mfma_f32_32x32x16_bf16 v[84:99], v[48:51], v[52:55], 0
    ds_read_b128 v[48:51], v11
    ds_read_b64_tr_b16 v[52:53], v36 offset:12288
    ds_read_b64_tr_b16 v[54:55], v36 offset:13312
    ds_read_b64_tr_b16 v[56:57], v36 offset:45056
    ds_read_b64_tr_b16 v[58:59], v36 offset:46080
    s_waitcnt lgkmcnt(10)
    v_mfma_f32_32x32x16_bf16 v[100:115], v[60:63], v[68:71], v[100:115]
    v_mfma_f32_32x32x16_bf16 v[84:99], v[60:63], v[64:67], v[84:99]
    ds_read_b128 v[60:63], v12
    ds_read_b64_tr_b16 v[64:65], v36 offset:16384
    ds_read_b64_tr_b16 v[66:67], v36 offset:17408
    ds_read_b64_tr_b16 v[68:69], v36 offset:49152
    ds_read_b64_tr_b16 v[70:71], v36 offset:50176
    s_waitcnt lgkmcnt(10)
    v_mfma_f32_32x32x16_bf16 v[100:115], v[72:75], v[80:83], v[100:115]
    v_mfma_f32_32x32x16_bf16 v[84:99], v[72:75], v[76:79], v[84:99]
    ds_read_b128 v[72:75], v13
    ds_read_b64_tr_b16 v[76:77], v36 offset:20480
    ds_read_b64_tr_b16 v[78:79], v36 offset:21504
    ds_read_b64_tr_b16 v[80:81], v36 offset:53248
    ds_read_b64_tr_b16 v[82:83], v36 offset:54272
    s_waitcnt lgkmcnt(10)
    v_mfma_f32_32x32x16_bf16 v[100:115], v[48:51], v[56:59], v[100:115]
    v_mfma_f32_32x32x16_bf16 v[84:99], v[48:51], v[52:55], v[84:99]
    ds_read_b128 v[48:51], v14
    ds_read_b64_tr_b16 v[52:53], v36 offset:24576
    ds_read_b64_tr_b16 v[54:55], v36 offset:25600
    ds_read_b64_tr_b16 v[56:57], v36 offset:57344
    ds_read_b64_tr_b16 v[58:59], v36 offset:58368
    s_waitcnt lgkmcnt(10)
    v_mfma_f32_32x32x16_bf16 v[100:115], v[60:63], v[68:71], v[100:115]
    v_mfma_f32_32x32x16_bf16 v[84:99], v[60:63], v[64:67], v[84:99]
    ds_read_b128 v[60:63], v15
    ds_read_b64_tr_b16 v[64:65], v36 offset:28672
    ds_read_b64_tr_b16 v[66:67], v36 offset:29696
    ds_read_b64_tr_b16 v[68:69], v36 offset:61440
    ds_read_b64_tr_b16 v[70:71], v36 offset:62464
    s_waitcnt lgkmcnt(10)
    v_mfma_f32_32x32x16_bf16 v[100:115], v[72:75], v[80:83], v[100:115]
    v_mfma_f32_32x32x16_bf16 v[84:99], v[72:75], v[76:79], v[84:99]
    s_cmp_lg_u32 s58, 0
    s_cbranch_scc1 HOOK
HOOKED:
    s_waitcnt lgkmcnt(5)
    v_mfma_f32_32x32x16_bf16 v[100:115], v[48:51], v[56:59], v[100:115]
    v_mfma_f32_32x32x16_bf16 v[84:99], v[48:51], v[52:55], v[84:99]
    s_waitcnt lgkmcnt(0)
    v_mfma_f32_32x32x16_bf16 v[100:115], v[60:63], v[68:71], v[100:115]
    v_mfma_f32_32x32x16_bf16 v[84:99], v[60:63], v[64:67], v[84:99]
    s_mov_b32 s82, 0xbfb8aa3b
    s_mov_b32 s83, 0xbfb8aa3b
    s_cmp_lg_u32 s58, 0
    s_cbranch_scc1 AU_DONE
    s_mov_b32 s81, 0x7f7e0000
    v_mov_b32 v4, 0x21800000
    s_nop 2
    s_nop 2
    v_cvt_pk_bf16_f32 v116, v100, v101
    v_xor_b32 v124, 0x80008000, v116
    v_cvt_pk_bf16_f32 v117, v102, v103
    v_xor_b32 v125, 0x80008000, v117
    v_cvt_pk_bf16_f32 v118, v104, v105
    v_xor_b32 v126, 0x80008000, v118
    v_cvt_pk_bf16_f32 v119, v106, v107
    v_xor_b32 v127, 0x80008000, v119
    v_cvt_pk_bf16_f32 v120, v108, v109
    v_xor_b32 v128, 0x80008000, v120
    v_cvt_pk_bf16_f32 v121, v110, v111
    v_xor_b32 v129, 0x80008000, v121
    v_cvt_pk_bf16_f32 v122, v112, v113
    v_xor_b32 v130, 0x80008000, v122
    v_cvt_pk_bf16_f32 v123, v114, v115
    v_xor_b32 v131, 0x80008000, v123
    v_fma_f32 v84, v84, s82, v4
    v_fma_f32 v85, v85, s82, v4
    v_fma_f32 v86, v86, s82, v4
    v_fma_f32 v87, v87, s82, v4
    v_med3_f32 v84, v84, -s81, s81
    v_med3_f32 v85, v85, -s81, s81
    v_med3_f32 v86, v86, -s81, s81
    v_med3_f32 v87, v87, -s81, s81
    v_sub_u32_sdwa v84, v84, sext(v124) dst_sel:DWORD dst_unused:UNUSED_PAD src0_sel:DWORD src1_sel:WORD_0
    v_sub_u32_sdwa v85, v85, sext(v124) dst_sel:DWORD dst_unused:UNUSED_PAD src0_sel:DWORD src1_sel:WORD_1
    v_sub_u32_sdwa v86, v86, sext(v125) dst_sel:DWORD dst_unused:UNUSED_PAD src0_sel:DWORD src1_sel:WORD_0
    v_sub_u32_sdwa v87, v87, sext(v125) dst_sel:DWORD dst_unused:UNUSED_PAD src0_sel:DWORD src1_sel:WORD_1
    v_mov_b32_sdwa v84, v116 dst_sel:WORD_0 dst_unused:UNUSED_PRESERVE src0_sel:WORD_0
    v_mov_b32_sdwa v85, v116 dst_sel:WORD_0 dst_unused:UNUSED_PRESERVE src0_sel:WORD_1
    v_mov_b32_sdwa v86, v117 dst_sel:WORD_0 dst_unused:UNUSED_PRESERVE src0_sel:WORD_0
    v_mov_b32_sdwa v87, v117 dst_sel:WORD_0 dst_unused:UNUSED_PRESERVE src0_sel:WORD_1
    s_nop 0
    buffer_store_dword v84, v20, s[20:23], 0 offen offset:0 sc1
    buffer_store_dword v85, v20, s[20:23], 0 offen offset:512 sc1
    buffer_store_dword v86, v20, s[20:23], 0 offen offset:1024 sc1
    buffer_store_dword v87, v20, s[20:23], 0 offen offset:1536 sc1
    v_fma_f32 v88, v88, s82, v4
    v_fma_f32 v89, v89, s82, v4
    v_fma_f32 v90, v90, s82, v4
    v_fma_f32 v91, v91, s82, v4
    v_med3_f32 v88, v88, -s81, s81
    v_med3_f32 v89, v89, -s81, s81
    v_med3_f32 v90, v90, -s81, s81
    v_med3_f32 v91, v91, -s81, s81
    v_sub_u32_sdwa v88, v88, sext(v126) dst_sel:DWORD dst_unused:UNUSED_PAD src0_sel:DWORD src1_sel:WORD_0
    v_sub_u32_sdwa v89, v89, sext(v126) dst_sel:DWORD dst_unused:UNUSED_PAD src0_sel:DWORD src1_sel:WORD_1
    v_sub_u32_sdwa v90, v90, sext(v127) dst_sel:DWORD dst_unused:UNUSED_PAD src0_sel:DWORD src1_sel:WORD_0
    v_sub_u32_sdwa v91, v91, sext(v127) dst_sel:DWORD dst_unused:UNUSED_PAD src0_sel:DWORD src1_sel:WORD_1
    v_mov_b32_sdwa v88, v118 dst_sel:WORD_0 dst_unused:UNUSED_PRESERVE src0_sel:WORD_0
    v_mov_b32_sdwa v89, v118 dst_sel:WORD_0 dst_unused:UNUSED_PRESERVE src0_sel:WORD_1
    v_mov_b32_sdwa v90, v119 dst_sel:WORD_0 dst_unused:UNUSED_PRESERVE src0_sel:WORD_0
    v_mov_b32_sdwa v91, v119 dst_sel:WORD_0 dst_unused:UNUSED_PRESERVE src0_sel:WORD_1
    s_nop 0
    buffer_store_dword v88, v21, s[20:23], 0 offen offset:0 sc1
    buffer_store_dword v89, v21, s[20:23], 0 offen offset:512 sc1
    buffer_store_dword v90, v21, s[20:23], 0 offen offset:1024 sc1
    buffer_store_dword v91, v21, s[20:23], 0 offen offset:1536 sc1
    v_fma_f32 v92, v92, s82, v4
    v_fma_f32 v93, v93, s82, v4
    v_fma_f32 v94, v94, s82, v4
    v_fma_f32 v95, v95, s82, v4
    v_med3_f32 v92, v92, -s81, s81
    v_med3_f32 v93, v93, -s81, s81
    v_med3_f32 v94, v94, -s81, s81
    v_med3_f32 v95, v95, -s81, s81
    v_sub_u32_sdwa v92, v92, sext(v128) dst_sel:DWORD dst_unused:UNUSED_PAD src0_sel:DWORD src1_sel:WORD_0
    v_sub_u32_sdwa v93, v93, sext(v128) dst_sel:DWORD dst_unused:UNUSED_PAD src0_sel:DWORD src1_sel:WORD_1
    v_sub_u32_sdwa v94, v94, sext(v129) dst_sel:DWORD dst_unused:UNUSED_PAD src0_sel:DWORD src1_sel:WORD_0
    v_sub_u32_sdwa v95, v95, sext(v129) dst_sel:DWORD dst_unused:UNUSED_PAD src0_sel:DWORD src1_sel:WORD_1
    v_mov_b32_sdwa v92, v120 dst_sel:WORD_0 dst_unused:UNUSED_PRESERVE src0_sel:WORD_0
    v_mov_b32_sdwa v93, v120 dst_sel:WORD_0 dst_unused:UNUSED_PRESERVE src0_sel:WORD_1
    v_mov_b32_sdwa v94, v121 dst_sel:WORD_0 dst_unused:UNUSED_PRESERVE src0_sel:WORD_0
    v_mov_b32_sdwa v95, v121 dst_sel:WORD_0 dst_unused:UNUSED_PRESERVE src0_sel:WORD_1
    s_nop 0
    buffer_store_dword v92, v22, s[20:23], 0 offen offset:0 sc1
    buffer_store_dword v93, v22, s[20:23], 0 offen offset:512 sc1
    buffer_store_dword v94, v22, s[20:23], 0 offen offset:1024 sc1
    buffer_store_dword v95, v22, s[20:23], 0 offen offset:1536 sc1
    v_fma_f32 v96, v96, s82, v4
    v_fma_f32 v97, v97, s82, v4
    v_fma_f32 v98, v98, s82, v4
    v_fma_f32 v99, v99, s82, v4
    v_med3_f32 v96, v96, -s81, s81
    v_med3_f32 v97, v97, -s81, s81
    v_med3_f32 v98, v98, -s81, s81
    v_med3_f32 v99, v99, -s81, s81
    v_sub_u32_sdwa v96, v96, sext(v130) dst_sel:DWORD dst_unused:UNUSED_PAD src0_sel:DWORD src1_sel:WORD_0
    v_sub_u32_sdwa v97, v97, sext(v130) dst_sel:DWORD dst_unused:UNUSED_PAD src0_sel:DWORD src1_sel:WORD_1
    v_sub_u32_sdwa v98, v98, sext(v131) dst_sel:DWORD dst_unused:UNUSED_PAD src0_sel:DWORD src1_sel:WORD_0
    v_sub_u32_sdwa v99, v99, sext(v131) dst_sel:DWORD dst_unused:UNUSED_PAD src0_sel:DWORD src1_sel:WORD_1
    v_mov_b32_sdwa v96, v122 dst_sel:WORD_0 dst_unused:UNUSED_PRESERVE src0_sel:WORD_0
    v_mov_b32_sdwa v97, v122 dst_sel:WORD_0 dst_unused:UNUSED_PRESERVE src0_sel:WORD_1
    v_mov_b32_sdwa v98, v123 dst_sel:WORD_0 dst_unused:UNUSED_PRESERVE src0_sel:WORD_0
    v_mov_b32_sdwa v99, v123 dst_sel:WORD_0 dst_unused:UNUSED_PRESERVE src0_sel:WORD_1
    s_nop 0
    buffer_store_dword v96, v23, s[20:23], 0 offen offset:0 sc1
    buffer_store_dword v97, v23, s[20:23], 0 offen offset:512 sc1
    buffer_store_dword v98, v23, s[20:23], 0 offen offset:1024 sc1
    buffer_store_dword v99, v23, s[20:23], 0 offen offset:1536 sc1
    s_barrier
    s_cmp_lt_u32 s3, 8
    s_cbranch_scc1 G_DRAIN
    v_lshrrev_b32 v4, 4, v1
    v_and_b32 v5, 15, v1
    v_xor_b32 v5, v5, v4
    v_lshlrev_b32 v5, 4, v5
    v_lshl_add_u32 v16, v4, 18, v5
    v_xor_b32 v17, 64, v16
    v_xor_b32 v18, 128, v16
    v_xor_b32 v19, 192, v16
    s_lshl_b32 s76, s2, 8
    s_lshl_b32 s77, s52, 16
    s_add_u32 s76, s76, s77
    s_lshl_b32 s78, s52, 12
    s_add_u32 s78, s78, 148480
    s_add_u32 m0, s78, 0
    s_add_u32 s77, s76, 0x0
    buffer_load_dwordx4 v16, s[8:11], s77 offen lds
    s_add_u32 m0, s78, 1024
    s_add_u32 s77, s76, 0x200000
    buffer_load_dwordx4 v17, s[8:11], s77 offen lds
    s_add_u32 m0, s78, 2048
    s_add_u32 s77, s76, 0x100000
    buffer_load_dwordx4 v18, s[8:11], s77 offen lds
    s_add_u32 m0, s78, 3072
    s_add_u32 s77, s76, 0x300000
    buffer_load_dwordx4 v19, s[8:11], s77 offen lds
G_DRAIN:
    s_branch ARRIVE
SORT:
    s_cmp_ge_u32 s3, 8
    s_cbranch_scc1 S_HELP
    v_lshlrev_b32 v11, 3, v0
    v_mov_b64 v[12:13], 0
    ds_write_b64 v11, v[12:13] offset:25600
    ds_write_b32 v7, v12 offset:29728
    v_lshlrev_b32 v6, 4, v0
    s_mul_i32 s76, s56, 12800
    s_add_u32 s77, s76, 8192
    s_waitcnt lgkmcnt(0)
    buffer_load_dwordx4 v[16:19], v6, s[44:47], s76 offen nt
    buffer_load_dwordx4 v[24:27], v6, s[40:43], s76 offen nt
    s_cmp_ge_u32 s3, 5
    s_cbranch_scc1 S_0
    buffer_load_dwordx4 v[20:23], v6, s[44:47], s77 offen nt
    buffer_load_dwordx4 v[28:31], v6, s[40:43], s77 offen nt
S_0:
    s_barrier
    v_and_b32 v164, 31, v0
    v_bfe_u32 v165, v0, 5, 1
    s_lshl_b32 s86, s52, 6
    v_lshl_add_u32 v166, v164, 1, s86
    v_lshl_add_u32 v166, v165, 11, v166
    buffer_load_ushort v152, v166, s[28:31], 0 offen offset:0
    buffer_load_ushort v153, v166, s[28:31], 0 offen offset:256
    buffer_load_ushort v154, v166, s[28:31], 0 offen offset:512
    buffer_load_ushort v155, v166, s[28:31], 0 offen offset:768
    buffer_load_ushort v156, v166, s[28:31], 0 offen offset:1024
    buffer_load_ushort v157, v166, s[28:31], 0 offen offset:1280
    buffer_load_ushort v158, v166, s[28:31], 0 offen offset:1536
    buffer_load_ushort v159, v166, s[28:31], 0 offen offset:1792
    s_mov_b64 s[20:21], s[16:17]
    s_load_dwordx2 s[12:13], s[0:1], 8
    s_load_dwordx2 s[24:25], s[0:1], 72
    s_load_dwordx2 s[48:49], s[0:1], 80
    s_mov_b32 s22, 0xc62a800
    s_mov_b32 s23, 0x20000
    s_mov_b32 s14, 0xc35000
    s_mov_b32 s15, 0x20000
    s_mov_b32 s26, 0x30d400
    s_mov_b32 s27, 0x20000
    s_mov_b32 s50, 0x100
    s_mov_b32 s51, 0x20000
    s_mov_b32 s54, 0
    s_mov_b32 s55, 0
    s_bfe_u32 s53, s3, 0x10002
    v_lshlrev_b32 v5, 7, v0
    v_mov_b32 v8, 0
    v_cmp_gt_u32 vcc, 288, v0
    s_mov_b64 s[78:79], vcc
    s_waitcnt vmcnt(8) lgkmcnt(0)
    v_lshlrev_b32_sdwa v9, 4, v16 dst_sel:DWORD dst_unused:UNUSED_PAD src0_sel:DWORD src1_sel:BYTE_0
    v_bfe_u32 v10, v16, 8, 2
    v_lshrrev_b32 v56, 7, v24
    v_lshl_or_b32 v48, v10, 2, v9
    v_and_b32 v56, 24, v56
    v_lshlrev_b32_e64 v9, v56, 1
    ds_add_rtn_u32 v32, v48, v9 offset:25600
    v_lshlrev_b32_sdwa v9, 4, v17 dst_sel:DWORD dst_unused:UNUSED_PAD src0_sel:DWORD src1_sel:BYTE_0
    v_bfe_u32 v10, v17, 8, 2
    v_lshrrev_b32 v57, 7, v25
    v_lshl_or_b32 v49, v10, 2, v9
    v_and_b32 v57, 24, v57
    v_lshlrev_b32_e64 v9, v57, 1
    ds_add_rtn_u32 v33, v49, v9 offset:25600
    v_lshlrev_b32_sdwa v9, 4, v18 dst_sel:DWORD dst_unused:UNUSED_PAD src0_sel:DWORD src1_sel:BYTE_0
    v_bfe_u32 v10, v18, 8, 2
    v_lshrrev_b32 v58, 7, v26
    v_lshl_or_b32 v50, v10, 2, v9
    v_and_b32 v58, 24, v58
    v_lshlrev_b32_e64 v9, v58, 1
    ds_add_rtn_u32 v34, v50, v9 offset:25600
    v_lshlrev_b32_sdwa v9, 4, v19 dst_sel:DWORD dst_unused:UNUSED_PAD src0_sel:DWORD src1_sel:BYTE_0
    v_bfe_u32 v10, v19, 8, 2
    v_lshrrev_b32 v59, 7, v27
    v_lshl_or_b32 v51, v10, 2, v9
    v_and_b32 v59, 24, v59
    v_lshlrev_b32_e64 v9, v59, 1
    ds_add_rtn_u32 v35, v51, v9 offset:25600
    v_lshrrev_b32 v9, 10, v16
    v_add_u32 v10, 0x1, v5
    v_lshl_or_b32 v10, v24, 18, v10
    v_add_u32 v40, v9, v10
    v_lshlrev_b32 v48, 1, v48
    v_lshrrev_b32 v9, 10, v17
    v_add_u32 v10, 0x21, v5
    v_lshl_or_b32 v10, v25, 18, v10
    v_add_u32 v41, v9, v10
    v_lshlrev_b32 v49, 1, v49
    v_lshrrev_b32 v9, 10, v18
    v_add_u32 v10, 0x41, v5
    v_lshl_or_b32 v10, v26, 18, v10
    v_add_u32 v42, v9, v10
    v_lshlrev_b32 v50, 1, v50
    v_lshrrev_b32 v9, 10, v19
    v_add_u32 v10, 0x61, v5
    v_lshl_or_b32 v10, v27, 18, v10
    v_add_u32 v43, v9, v10
    v_lshlrev_b32 v51, 1, v51
    s_waitcnt lgkmcnt(3)
    v_bfe_u32 v32, v32, v56, 8
    s_waitcnt lgkmcnt(2)
    v_bfe_u32 v33, v33, v57, 8
    s_waitcnt lgkmcnt(1)
    v_bfe_u32 v34, v34, v58, 8
    s_waitcnt lgkmcnt(0)
    v_bfe_u32 v35, v35, v59, 8
    v_max3_u32 v8, v8, v32, v33
    v_max3_u32 v8, v8, v34, v35
    s_mov_b64 exec, s[78:79]
    s_cbranch_execz S_1
    v_lshlrev_b32_sdwa v9, 4, v20 dst_sel:DWORD dst_unused:UNUSED_PAD src0_sel:DWORD src1_sel:BYTE_0
    v_bfe_u32 v10, v20, 8, 2
    v_lshrrev_b32 v60, 7, v28
    v_lshl_or_b32 v52, v10, 2, v9
    v_and_b32 v60, 24, v60
    v_lshlrev_b32_e64 v9, v60, 1
    ds_add_rtn_u32 v36, v52, v9 offset:25600
    v_lshlrev_b32_sdwa v9, 4, v21 dst_sel:DWORD dst_unused:UNUSED_PAD src0_sel:DWORD src1_sel:BYTE_0
    v_bfe_u32 v10, v21, 8, 2
    v_lshrrev_b32 v61, 7, v29
    v_lshl_or_b32 v53, v10, 2, v9
    v_and_b32 v61, 24, v61
    v_lshlrev_b32_e64 v9, v61, 1
    ds_add_rtn_u32 v37, v53, v9 offset:25600
    v_lshlrev_b32_sdwa v9, 4, v22 dst_sel:DWORD dst_unused:UNUSED_PAD src0_sel:DWORD src1_sel:BYTE_0
    v_bfe_u32 v10, v22, 8, 2
    v_lshrrev_b32 v62, 7, v30
    v_lshl_or_b32 v54, v10, 2, v9
    v_and_b32 v62, 24, v62
    v_lshlrev_b32_e64 v9, v62, 1
    ds_add_rtn_u32 v38, v54, v9 offset:25600
    v_lshlrev_b32_sdwa v9, 4, v23 dst_sel:DWORD dst_unused:UNUSED_PAD src0_sel:DWORD src1_sel:BYTE_0
    v_bfe_u32 v10, v23, 8, 2
    v_lshrrev_b32 v63, 7, v31
    v_lshl_or_b32 v55, v10, 2, v9
    v_and_b32 v63, 24, v63
    v_lshlrev_b32_e64 v9, v63, 1
    ds_add_rtn_u32 v39, v55, v9 offset:25600
    v_lshrrev_b32 v9, 10, v20
    v_add_u32 v10, 0x10001, v5
    v_lshl_or_b32 v10, v28, 18, v10
    v_add_u32 v44, v9, v10
    v_lshlrev_b32 v52, 1, v52
    v_lshrrev_b32 v9, 10, v21
    v_add_u32 v10, 0x10021, v5
    v_lshl_or_b32 v10, v29, 18, v10
    v_add_u32 v45, v9, v10
    v_lshlrev_b32 v53, 1, v53
    v_lshrrev_b32 v9, 10, v22
    v_add_u32 v10, 0x10041, v5
    v_lshl_or_b32 v10, v30, 18, v10
    v_add_u32 v46, v9, v10
    v_lshlrev_b32 v54, 1, v54
    v_lshrrev_b32 v9, 10, v23
    v_add_u32 v10, 0x10061, v5
    v_lshl_or_b32 v10, v31, 18, v10
    v_add_u32 v47, v9, v10
    v_lshlrev_b32 v55, 1, v55
    s_waitcnt lgkmcnt(3)
    v_bfe_u32 v36, v36, v60, 8
    s_waitcnt lgkmcnt(2)
    v_bfe_u32 v37, v37, v61, 8
    s_waitcnt lgkmcnt(1)
    v_bfe_u32 v38, v38, v62, 8
    s_waitcnt lgkmcnt(0)
    v_bfe_u32 v39, v39, v63, 8
    v_max3_u32 v8, v8, v36, v37
    v_max3_u32 v8, v8, v38, v39
S_1:
    s_mov_b64 exec, -1
    v_cmp_lt_u32 vcc, 62, v8
    s_cbranch_vccz S_1B
    v_mov_b32 v9, -1
    ds_write_b32 v7, v9 offset:29728
    s_waitcnt lgkmcnt(0)
S_1B:
    v_lshlrev_b32 v9, 4, v1
    v_mov_b64 v[92:93], 0
    s_barrier
    ds_read_b64 v[12:13], v11 offset:25600
    ds_read_b128 v[76:79], v9 offset:25600
    ds_read_b128 v[80:83], v9 offset:26624
    ds_read_b128 v[84:87], v9 offset:27648
    ds_read_b128 v[88:91], v9 offset:28672
    ds_read_b32 v15, v7 offset:29728
    s_waitcnt lgkmcnt(5)
    v_sad_u8 v10, v12, 0, 0
    v_sad_u8 v8, v13, 0, v10
    v_mov_b32 v14, v8
    s_cmp_gt_u32 s3, 0
    s_cselect_b32 exec_lo, -1, 0
    s_cmp_gt_u32 s3, 1
    s_cselect_b32 exec_hi, -1, 0
    s_waitcnt lgkmcnt(4)
    v_sad_u8 v92, v76, 0, v92
    v_sad_u8 v93, v77, 0, v93
    v_sad_u8 v92, v78, 0, v92
    v_sad_u8 v93, v79, 0, v93
    s_cmp_gt_u32 s3, 2
    s_cselect_b32 exec_lo, -1, 0
    s_cmp_gt_u32 s3, 3
    s_cselect_b32 exec_hi, -1, 0
    s_waitcnt lgkmcnt(3)
    v_sad_u8 v92, v80, 0, v92
    v_sad_u8 v93, v81, 0, v93
    v_sad_u8 v92, v82, 0, v92
    v_sad_u8 v93, v83, 0, v93
    s_cmp_gt_u32 s3, 4
    s_cselect_b32 exec_lo, -1, 0
    s_cmp_gt_u32 s3, 5
    s_cselect_b32 exec_hi, -1, 0
    s_waitcnt lgkmcnt(2)
    v_sad_u8 v92, v84, 0, v92
    v_sad_u8 v93, v85, 0, v93
    v_sad_u8 v92, v86, 0, v92
    v_sad_u8 v93, v87, 0, v93
    s_cmp_gt_u32 s3, 6
    s_cselect_b32 exec_lo, -1, 0
    s_cmp_gt_u32 s3, 7
    s_cselect_b32 exec_hi, -1, 0
    s_waitcnt lgkmcnt(1)
    v_sad_u8 v92, v88, 0, v92
    v_sad_u8 v93, v89, 0, v93
    v_sad_u8 v92, v90, 0, v92
    v_sad_u8 v93, v91, 0, v93
    s_mov_b64 exec, -1
    v_add_u32 v92, v92, v93
    s_nop 1
    v_add_u32_dpp v92, v92, v92 row_shr:1 row_mask:0xf bank_mask:0xf
    v_add_u32_dpp v14, v14, v14 row_shr:1 row_mask:0xf bank_mask:0xf
    s_nop 0
    v_add_u32_dpp v92, v92, v92 row_shr:2 row_mask:0xf bank_mask:0xf
    v_add_u32_dpp v14, v14, v14 row_shr:2 row_mask:0xf bank_mask:0xf
    s_nop 0
    v_add_u32_dpp v92, v92, v92 row_shr:4 row_mask:0xf bank_mask:0xf
    v_add_u32_dpp v14, v14, v14 row_shr:4 row_mask:0xf bank_mask:0xf
    s_nop 0
    v_add_u32_dpp v92, v92, v92 row_shr:8 row_mask:0xf bank_mask:0xf
    v_add_u32_dpp v14, v14, v14 row_shr:8 row_mask:0xf bank_mask:0xf
    s_nop 0
    v_add_u32_dpp v92, v92, v92 row_bcast:15 row_mask:0xa bank_mask:0xf
    v_add_u32_dpp v14, v14, v14 row_bcast:15 row_mask:0xa bank_mask:0xf
    s_nop 0
    v_add_u32_dpp v92, v92, v92 row_bcast:31 row_mask:0xc bank_mask:0xf
    v_add_u32_dpp v14, v14, v14 row_bcast:31 row_mask:0xc bank_mask:0xf
    s_nop 0
    v_readlane_b32 s81, v92, 63
    v_sub_u32 v14, v14, v8
    s_waitcnt lgkmcnt(0)
    v_or_b32 v73, v12, v15
    v_or_b32 v75, v13, v15
    v_add_u32 v14, s81, v14
    v_mov_b32 v72, v14
    v_add_u32 v74, v14, v10
    v_mov_b32 v64, v14
    v_mov_b32 v65, v12
    v_mov_b32 v66, v74
    v_mov_b32 v67, v13
    ds_write_b128 v6, v[64:67] offset:29952
    s_waitcnt lgkmcnt(0)
    s_barrier
    ds_read_b64 v[76:77], v48 offset:29952
    ds_read_b64 v[78:79], v49 offset:29952
    ds_read_b64 v[80:81], v50 offset:29952
    ds_read_b64 v[82:83], v51 offset:29952
    s_cmp_ge_u32 s3, 5
    s_cbranch_scc1 S_2
    s_mov_b64 exec, s[78:79]
    ds_read_b64 v[84:85], v52 offset:29952
    ds_read_b64 v[86:87], v53 offset:29952
    ds_read_b64 v[88:89], v54 offset:29952
    ds_read_b64 v[90:91], v55 offset:29952
    s_mov_b64 exec, -1
    s_waitcnt lgkmcnt(7)
    v_bfe_u32 v9, v77, 0, v56
    v_sad_u8 v9, v9, 0, v76
    v_add_lshl_u32 v9, v9, v32, 2
    ds_write_b32 v9, v40 offset:38144
    s_waitcnt lgkmcnt(7)
    v_bfe_u32 v9, v79, 0, v57
    v_sad_u8 v9, v9, 0, v78
    v_add_lshl_u32 v9, v9, v33, 2
    ds_write_b32 v9, v41 offset:38144
    s_waitcnt lgkmcnt(7)
    v_bfe_u32 v9, v81, 0, v58
    v_sad_u8 v9, v9, 0, v80
    v_add_lshl_u32 v9, v9, v34, 2
    ds_write_b32 v9, v42 offset:38144
    s_waitcnt lgkmcnt(7)
    v_bfe_u32 v9, v83, 0, v59
    v_sad_u8 v9, v9, 0, v82
    v_add_lshl_u32 v9, v9, v35, 2
    ds_write_b32 v9, v43 offset:38144
    s_mov_b64 exec, s[78:79]
    s_waitcnt lgkmcnt(7)
    v_bfe_u32 v9, v85, 0, v60
    v_sad_u8 v9, v9, 0, v84
    v_add_lshl_u32 v9, v9, v36, 2
    ds_write_b32 v9, v44 offset:38144
    s_waitcnt lgkmcnt(7)
    v_bfe_u32 v9, v87, 0, v61
    v_sad_u8 v9, v9, 0, v86
    v_add_lshl_u32 v9, v9, v37, 2
    ds_write_b32 v9, v45 offset:38144
    s_waitcnt lgkmcnt(7)
    v_bfe_u32 v9, v89, 0, v62
    v_sad_u8 v9, v9, 0, v88
    v_add_lshl_u32 v9, v9, v38, 2
    ds_write_b32 v9, v46 offset:38144
    s_waitcnt lgkmcnt(7)
    v_bfe_u32 v9, v91, 0, v63
    v_sad_u8 v9, v9, 0, v90
    v_add_lshl_u32 v9, v9, v39, 2
    ds_write_b32 v9, v47 offset:38144
    s_branch S_3
S_2:
    s_waitcnt lgkmcnt(3)
    v_bfe_u32 v9, v77, 0, v56
    v_sad_u8 v9, v9, 0, v76
    v_add_lshl_u32 v9, v9, v32, 2
    ds_write_b32 v9, v40 offset:38144
    s_waitcnt lgkmcnt(3)
    v_bfe_u32 v9, v79, 0, v57
    v_sad_u8 v9, v9, 0, v78
    v_add_lshl_u32 v9, v9, v33, 2
    ds_write_b32 v9, v41 offset:38144
    s_waitcnt lgkmcnt(3)
    v_bfe_u32 v9, v81, 0, v58
    v_sad_u8 v9, v9, 0, v80
    v_add_lshl_u32 v9, v9, v34, 2
    ds_write_b32 v9, v42 offset:38144
    s_waitcnt lgkmcnt(3)
    v_bfe_u32 v9, v83, 0, v59
    v_sad_u8 v9, v9, 0, v82
    v_add_lshl_u32 v9, v9, v35, 2
    ds_write_b32 v9, v43 offset:38144
S_3:
    s_mov_b64 exec, -1
    s_add_u32 s76, s76, 0x620000
    s_add_u32 s77, s77, 0x620000
    s_lshl_b32 s80, s56, 13
    s_add_u32 s80, s80, 0x7d0000
    s_waitcnt vmcnt(0)
    buffer_store_dwordx4 v[72:75], v6, s[16:19], s80 offen sc1
    s_waitcnt lgkmcnt(0)
    s_barrier
    ds_read_b128 v[64:67], v6 offset:38144
    ds_read_b128 v[68:71], v6 offset:46336
    s_waitcnt lgkmcnt(1)
    buffer_store_dwordx4 v[64:67], v6, s[16:19], s76 offen sc1
    s_waitcnt lgkmcnt(0)
    s_mov_b64 exec, s[78:79]
    s_cbranch_execz S_4
    buffer_store_dwordx4 v[68:71], v6, s[16:19], s77 offen sc1
S_4:
    s_mov_b64 exec, -1
    s_branch ARRIVE
S_HELP:
    s_waitcnt lgkmcnt(0)
    s_mov_b64 s[32:33], s[92:93]
    s_mov_b64 s[36:37], s[94:95]
    s_mov_b64 s[20:21], s[16:17]
    s_load_dwordx2 s[12:13], s[0:1], 8
    s_load_dwordx2 s[24:25], s[0:1], 72
    s_load_dwordx2 s[48:49], s[0:1], 80
    s_mov_b32 s22, 0xc62a800
    s_mov_b32 s23, 0x20000
    s_mov_b32 s14, 0xc35000
    s_mov_b32 s15, 0x20000
    s_mov_b32 s26, 0x30d400
    s_mov_b32 s27, 0x20000
    s_mov_b32 s50, 0x100
    s_mov_b32 s51, 0x20000
    s_mov_b32 s54, 0
    s_mov_b32 s55, 0
    s_bfe_u32 s53, s3, 0x10002
    s_barrier
    s_lshl_b32 s76, s56, 4
    s_add_u32 s76, s76, s3
    s_cmp_lg_u32 s76, 8
    s_cbranch_scc1 S_H2
    v_mov_b32 v5, 1
    s_mov_b64 exec, 1
    s_waitcnt vmcnt(0) lgkmcnt(0)
    buffer_store_dword v5, v7, s[48:51], 0 offen sc1
    s_mov_b64 exec, -1
S_H2:
    s_waitcnt lgkmcnt(0)
    s_lshl_b32 s79, s52, 13
    s_add_u32 m0, s79, 73728
    s_nop 0
    buffer_load_dwordx4 v2, s[32:35], s79 offen offset:0 lds
    buffer_load_dwordx4 v2, s[32:35], s79 offen offset:1024 lds
    buffer_load_dwordx4 v2, s[32:35], s79 offen offset:2048 lds
    buffer_load_dwordx4 v2, s[32:35], s79 offen offset:3072 lds
    s_add_u32 m0, s79, 106496
    s_nop 0
    buffer_load_dwordx4 v2, s[36:39], s79 offen offset:0 lds
    buffer_load_dwordx4 v2, s[36:39], s79 offen offset:1024 lds
    buffer_load_dwordx4 v2, s[36:39], s79 offen offset:2048 lds
    buffer_load_dwordx4 v2, s[36:39], s79 offen offset:3072 lds
    s_add_u32 s79, s79, 4096
    s_add_u32 m0, s79, 73728
    s_nop 0
    buffer_load_dwordx4 v2, s[32:35], s79 offen offset:0 lds
    buffer_load_dwordx4 v2, s[32:35], s79 offen offset:1024 lds
    buffer_load_dwordx4 v2, s[32:35], s79 offen offset:2048 lds
    buffer_load_dwordx4 v2, s[32:35], s79 offen offset:3072 lds
    s_add_u32 m0, s79, 106496
    s_nop 0
    buffer_load_dwordx4 v2, s[36:39], s79 offen offset:0 lds
    buffer_load_dwordx4 v2, s[36:39], s79 offen offset:1024 lds
    buffer_load_dwordx4 v2, s[36:39], s79 offen offset:2048 lds
    buffer_load_dwordx4 v2, s[36:39], s79 offen offset:3072 lds
    s_barrier
    v_lshrrev_b32 v4, 4, v1
    v_and_b32 v5, 15, v1
    v_xor_b32 v5, v5, v4
    v_lshlrev_b32 v5, 4, v5
    v_lshl_add_u32 v16, v4, 18, v5
    v_xor_b32 v17, 64, v16
    v_xor_b32 v18, 128, v16
    v_xor_b32 v19, 192, v16
    s_lshl_b32 s76, s2, 8
    s_lshl_b32 s77, s52, 16
    s_add_u32 s76, s76, s77
    s_lshl_b32 s78, s52, 12
    s_add_u32 s78, s78, 148480
    s_add_u32 m0, s78, 0
    s_add_u32 s77, s76, 0x0
    buffer_load_dwordx4 v16, s[8:11], s77 offen lds
    s_add_u32 m0, s78, 1024
    s_add_u32 s77, s76, 0x200000
    buffer_load_dwordx4 v17, s[8:11], s77 offen lds
    s_add_u32 m0, s78, 2048
    s_add_u32 s77, s76, 0x100000
    buffer_load_dwordx4 v18, s[8:11], s77 offen lds
    s_add_u32 m0, s78, 3072
    s_add_u32 s77, s76, 0x300000
    buffer_load_dwordx4 v19, s[8:11], s77 offen lds
    s_barrier
    s_barrier
ARRIVE:
    s_cmp_lt_u32 s3, 8
    s_cbranch_scc1 NODE
    s_cmp_eq_u32 s3, 8
    s_cbranch_scc1 SIGNAL
    s_waitcnt vmcnt(0)
    s_barrier
    s_cmp_ge_u32 s56, 125
    s_cbranch_scc1 HELP
    s_barrier
    s_branch HELP
SIGNAL:
    s_load_dword s96, s[48:49], 0
    s_and_b32 s76, s56, 7
    s_lshl_b32 s76, s76, 7
    s_bfe_u32 s77, s56, 0x40003
    s_lshl_b32 s77, s77, 2
    s_add_u32 s76, s76, s77
    s_lshr_b32 s77, s56, 7
    s_lshl_b32 s77, s77, 10
    s_add_u32 s76, s76, s77
    s_add_u32 s76, s76, 0x7b0000
    v_lshl_add_u32 v33, v1, 11, s76
    s_and_b32 s76, s56, 15
    s_lshl_b32 s76, s76, 11
    s_add_u32 s76, s76, 0x7b0000
    v_lshrrev_b32 v32, 2, v1
    v_and_b32 v34, 3, v1
    v_lshlrev_b32 v34, 4, v34
    v_lshl_add_u32 v32, v32, 7, v34
    v_add_u32 v32, s76, v32
    v_mov_b32 v35, 1
    s_mov_b32 vcc_lo, 0x88800000
    s_mov_b32 vcc_hi, 0
    v_cndmask_b32_e64 v36, 0, 1, vcc
    s_mov_b64 exec, 1
    s_waitcnt lgkmcnt(0)
    v_mov_b32 v24, s96
    s_mov_b32 s81, 0
NC_LA:
    v_cmp_eq_u32 vcc, 0, v24
    s_cbranch_vccz NC_EA
    s_add_u32 s81, s81, 1
    s_cmp_gt_u32 s81, 0x100000
    s_cbranch_scc1 NC_EA
    buffer_load_dword v24, v7, s[48:51], 0 offen sc1
    s_waitcnt vmcnt(0)
    s_branch NC_LA
NC_EA:
    s_mov_b32 exec_lo, 0xffff
    s_mov_b32 exec_hi, 0x0
    s_mov_b32 s81, 0
    s_waitcnt vmcnt(0)
    s_barrier
    buffer_store_dword v35, v33, s[16:19], 0 offen sc1
    s_mov_b64 exec, -1
    s_cmp_ge_u32 s56, 125
    s_cbranch_scc1 SIG2
    s_barrier
SIG2:
    s_mov_b32 s81, 0
    s_mov_b32 exec_hi, 0
WAITF1:
    buffer_load_dwordx4 v[40:43], v32, s[16:19], 0 offen sc1
    s_waitcnt vmcnt(0)
    v_or_b32 v43, v43, v36
    v_and_b32 v40, v40, v41
    v_and_b32 v42, v42, v43
    v_and_b32 v40, v40, v42
    v_cmpx_ne_u32 vcc, 1, v40
    s_cbranch_execz ALLIN1
    s_sleep 2
    s_add_u32 s81, s81, 1
    s_cmp_lt_u32 s81, 0x100000
    s_cbranch_scc1 WAITF1
ALLIN1:
    s_mov_b64 exec, -1
    s_branch HELP
NODE:
    s_lshl_b32 s81, s53, 13
    s_add_u32 s81, s81, 148480
    v_lshrrev_b32 v5, 5, v1
    v_bfe_u32 v4, v1, 2, 2
    v_lshl_add_u32 v36, v5, 3, v4
    v_lshlrev_b32 v36, 8, v36
    v_xor_b32 v4, s52, v4
    v_lshl_add_u32 v36, v4, 6, v36
    v_bfe_u32 v4, v1, 4, 1
    v_lshl_add_u32 v36, v4, 5, v36
    v_and_b32 v4, 3, v1
    v_lshl_add_u32 v36, v4, 3, v36
    v_add_u32 v36, 73728, v36
    v_and_b32 v4, 15, v1
    v_xor_b32 v4, v4, v5
    v_lshlrev_b32 v4, 4, v4
    v_and_b32 v6, 31, v1
    v_lshl_add_u32 v4, v6, 8, v4
    v_add_u32 v8, s81, v4
    v_xor_b32 v9, 32, v8
    v_xor_b32 v10, 64, v8
    v_xor_b32 v11, 96, v8
    v_xor_b32 v12, 128, v8
    v_xor_b32 v13, 160, v8
    v_xor_b32 v14, 192, v8
    v_xor_b32 v15, 224, v8
    s_lshl_b32 s78, s52, 7
    v_lshl_add_u32 v165, v164, 2, s78
    v_cvt_f32_u32 v165, v165
    v_mul_f32 v165, 0x00800000, v165
    v_lshrrev_b32 v165, 16, v165
    v_mov_b32 v164, 0x08800500
    s_mov_b32 exec_lo, 0
    v_mov_b64 v[164:165], 0
    s_mov_b32 exec_lo, -1
    s_mov_b32 s88, 0x0000ffff
    s_mov_b32 s89, 0x0000ffff
    s_cmp_lt_u32 s56, 125
    s_cselect_b32 s58, 2, 1
    s_mov_b32 s82, 0xbfb8aa3b
    v_lshlrev_b32 v152, 16, v152
    v_lshlrev_b32 v153, 16, v153
    v_lshlrev_b32 v154, 16, v154
    v_lshlrev_b32 v155, 16, v155
    v_lshlrev_b32 v156, 16, v156
    v_lshlrev_b32 v157, 16, v157
    v_lshlrev_b32 v158, 16, v158
    v_lshlrev_b32 v159, 16, v159
    v_mul_f32 v152, s82, v152
    v_mul_f32 v153, s82, v153
    v_mul_f32 v154, s82, v154
    v_mul_f32 v155, s82, v155
    v_mul_f32 v156, s82, v156
    v_mul_f32 v157, s82, v157
    v_mul_f32 v158, s82, v158
    v_mul_f32 v159, s82, v159
    v_cvt_pk_bf16_f32 v32, v152, v153
    v_cvt_pk_bf16_f32 v33, v154, v155
    v_cvt_pk_bf16_f32 v34, v156, v157
    v_cvt_pk_bf16_f32 v35, v158, v159
ROUND:
    v_mov_b64 v[24:25], 0
    v_mov_b64 v[26:27], 0
    v_mov_b64 v[28:29], 0
    v_mov_b64 v[30:31], 0
    v_lshlrev_b32 v150, 4, v0
    v_mov_b32 v152, 0x43004300
    v_mov_b32 v153, 0x43004300
    v_mov_b32 v154, 0x43004300
    v_mov_b32 v155, 0x43004300
    ds_write_b128 v150, v[152:155] offset:1024
    ds_write_b128 v150, v[24:27] offset:9216
    s_cmp_lg_u32 s3, 0
    s_cbranch_scc1 R_Z
    ds_write_b128 v150, v[24:27]
R_Z:
    v_mov_b32 v147, 0x43004300
    v_mov_b32 v17, 0x3f80
    v_mov_b32 v19, 0x3f80
    v_bfe_u32 v166, v0, 5, 1
    v_and_b32 v1, 31, v0
    v_lshlrev_b32 v3, 4, v166
    v_lshl_add_u32 v3, v1, 5, v3
    v_lshlrev_b32 v1, 2, v1
    v_bfe_u32 v4, v0, 2, 2
    v_lshl_add_u32 v4, v166, 3, v4
    v_lshlrev_b32 v4, 5, v4
    v_and_b32 v5, 1, v0
    v_lshl_add_u32 v4, v5, 4, v4
    v_bfe_u32 v5, v0, 1, 1
    v_lshl_add_u32 v4, v5, 3, v4
    v_and_b32 v146, 3, v0
    v_lshlrev_b32 v146, 3, v146
    v_mov_b32 v145, 48
    s_mov_b32 s60, 0
    s_mov_b32 s62, 0
    s_mov_b32 s84, 0x0c010c00
    s_mov_b32 s85, 0x0c030c02
    s_mov_b32 s79, 0x10001
    s_cmp_lg_u32 s54, 0
    s_cbranch_scc1 SLOWSRC
    v_lshrrev_b32 v134, 2, v0
    v_mov_b32 v135, v146
    s_lshl_b32 s76, s2, 5
    s_add_u32 s76, s76, 0x7d0000
    v_lshl_add_u32 v148, v134, 13, v135
    v_add_u32 v148, s76, v148
    v_mul_u32_u24 v136, 12800, v134
    v_lshlrev_b32 v134, 3, v136
    v_add_u32 v136, 0x620000, v136
    s_waitcnt vmcnt(0) lgkmcnt(0)
    s_barrier
    s_branch CORE
HOOK:
    s_barrier
    s_cmp_eq_u32 s58, 2
    s_cbranch_scc1 HOOKED
    buffer_load_dwordx2 v[132:133], v148, s[16:19], 0 offen sc1
    s_branch HOOKED
AU_DONE:
    s_cmp_lg_u32 s58, 2
    s_cbranch_scc1 AU_G
    s_barrier
    buffer_load_dwordx2 v[132:133], v148, s[16:19], 0 offen sc1
AU_G:
    s_waitcnt vmcnt(0)
    v_lshl_add_u32 v136, v132, 2, v136
    v_sad_u8 v137, v133, 0, 0
    buffer_load_dwordx4 v[116:119], v136, s[16:19], 0 offen offset:0 sc1
    v_cmpx_lt_u32 vcc, 4, v137
    s_cbranch_execz RECD
    buffer_load_dwordx4 v[120:123], v136, s[16:19], 0 offen offset:16 sc1
    v_cmpx_lt_u32 vcc, 8, v137
    s_cbranch_execz RECD
    buffer_load_dwordx4 v[124:127], v136, s[16:19], 0 offen offset:32 sc1
    v_cmpx_lt_u32 vcc, 12, v137
    s_cbranch_execz RECD
    buffer_load_dwordx4 v[128:131], v136, s[16:19], 0 offen offset:48 sc1
RECD:
    s_mov_b64 exec, -1
ALLOC:
    v_perm_b32 v138, v133, v133, s84
    v_perm_b32 v139, v133, v133, s85
    ds_add_rtn_u64 v[140:141], v135, v[138:139] offset:64
    s_mov_b64 exec, 1
    ds_inc_u32 v7, v145 offset:104
    s_mov_b64 exec, -1
    v_sad_u8 v137, v133, 0, 0
WA_C:
    ds_read_b32 v148, v7 offset:104
    s_waitcnt lgkmcnt(0)
    v_readfirstlane_b32 s80, v148
    s_cmp_lt_u32 s80, 8
    s_cbranch_scc1 WA_C
    ds_read_b64 v[148:149], v146 offset:64
    ds_read_b64 v[142:143], v135 offset:64
    v_lshrrev_b32 v144, 4, v135
    v_bfe_u32 v135, v135, 3, 1
    s_waitcnt lgkmcnt(1)
    v_add_u32 v148, v148, v149
    v_add_u32_sdwa v148, v148, v148 dst_sel:DWORD dst_unused:UNUSED_PAD src0_sel:WORD_0 src1_sel:WORD_1
    v_add_u32 v148, 31, v148
    v_lshrrev_b32 v148, 4, v148
    v_and_b32 v148, -2, v148
    s_nop 0
    v_readlane_b32 s68, v148, 0
    v_readlane_b32 s69, v148, 1
    v_readlane_b32 s70, v148, 2
    v_readlane_b32 s71, v148, 3
    s_sub_i32 s72, s68, 1
    s_sub_i32 s73, s70, 1
    s_max_i32 s72, s72, s69
    s_max_i32 s73, s73, s71
    s_add_u32 s74, s72, s73
    s_cmp_gt_u32 s74, 62
    s_cbranch_scc1 OVF
    s_waitcnt lgkmcnt(0)
    v_sub_u32 v142, v142, v138
    v_sub_u32 v143, v143, v139
    v_lshl_add_u32 v140, v142, 16, v140
    v_lshl_add_u32 v141, v143, 16, v141
    v_add_u32_sdwa v142, v142, v142 dst_sel:DWORD dst_unused:UNUSED_PAD src0_sel:WORD_0 src1_sel:WORD_1
    v_mad_u32_u24 v144, v144, s72, v135
    v_mad_u32_u24 v141, v142, s79, v141
    v_lshlrev_b32 v144, 7, v144
    v_lshlrev_b64 v[140:141], 2, v[140:141]
    s_cmp_eq_u32 s53, 0
    s_cselect_b32 s63, 0, s72
    s_cselect_b32 s64, s68, s70
    s_cselect_b32 s65, s69, s71
    s_cselect_b32 s61, s72, s73
    s_sub_u32 s66, s64, 1
    s_sub_u32 s67, s65, 1
    s_lshl_b32 s76, s63, 7
    s_add_u32 s76, s76, 1024
    v_add_u32 v1, s76, v1
    s_lshl_b32 s76, s63, 10
    s_add_u32 s77, s76, 17408
    v_add_u32 v3, s77, v3
    v_add_u32 v4, s77, v4
    v_add_u32 v2, 64512, v3
    v_or_b32 v6, 24, v4
    v_add_u32 v5, 1024, v6
    v_cndmask_b32_e64 v5, v5, v4, s[88:89]
    v_cndmask_b32_e64 v6, v4, v6, s[88:89]
    v_mov_b32 v4, 0xdddd
    s_mov_b32 s76, 0x1ffff
    s_mov_b32 s77, 0xff80
    s_mov_b32 s78, 0x007f007f
    s_mov_b32 s86, 128
PLACE:
    s_waitcnt vmcnt(0)
    v_cmpx_lt_u32 vcc, 0, v137
    s_cbranch_execz PLACED
    v_and_b32_sdwa v150, v116, v145 dst_sel:DWORD dst_unused:UNUSED_PAD src0_sel:BYTE_3 src1_sel:DWORD
    v_lshrrev_b32 v151, 18, v116
    v_lshl_or_b32 v151, v151, 9, v151
    v_and_b32 v152, s76, v116
    v_lshrrev_b64 v[148:149], v150, v[140:141]
    v_and_or_b32 v151, v151, s78, v147
    v_add_u16 v148, 0, v148
    v_add_u32 v152, v152, v134
    v_and_b32 v149, s77, v148
    v_cmp_gt_u32 vcc, s86, v148
    v_add3_u32 v148, v148, v149, v144
    ds_write2st64_b32 v148, v151, v152 offset0:4 offset1:36
    s_and_saveexec_b64 s[80:81], vcc
    buffer_load_ubyte v163, v152, s[12:15], 0 offen
    s_mov_b64 exec, s[80:81]
    v_cmpx_lt_u32 vcc, 1, v137
    s_cbranch_execz PLACED
    v_and_b32_sdwa v156, v117, v145 dst_sel:DWORD dst_unused:UNUSED_PAD src0_sel:BYTE_3 src1_sel:DWORD
    v_lshrrev_b32 v157, 18, v117
    v_lshl_or_b32 v157, v157, 9, v157
    v_and_b32 v158, s76, v117
    v_lshrrev_b64 v[154:155], v156, v[140:141]
    v_and_or_b32 v157, v157, s78, v147
    v_add_u16 v154, 4, v154
    v_add_u32 v158, v158, v134
    v_and_b32 v155, s77, v154
    v_cmp_gt_u32 vcc, s86, v154
    v_add3_u32 v154, v154, v155, v144
    ds_write2st64_b32 v154, v157, v158 offset0:4 offset1:36
    s_and_saveexec_b64 s[80:81], vcc
    buffer_load_ubyte v163, v158, s[12:15], 0 offen
    s_mov_b64 exec, s[80:81]
    v_cmpx_lt_u32 vcc, 2, v137
    s_cbranch_execz PLACED
    v_and_b32_sdwa v150, v118, v145 dst_sel:DWORD dst_unused:UNUSED_PAD src0_sel:BYTE_3 src1_sel:DWORD
    v_lshrrev_b32 v151, 18, v118
    v_lshl_or_b32 v151, v151, 9, v151
    v_and_b32 v152, s76, v118
    v_lshrrev_b64 v[148:149], v150, v[140:141]
    v_and_or_b32 v151, v151, s78, v147
    v_add_u16 v148, 8, v148
    v_add_u32 v152, v152, v134
    v_and_b32 v149, s77, v148
    v_add3_u32 v148, v148, v149, v144
    ds_write2st64_b32 v148, v151, v152 offset0:4 offset1:36
    v_cmpx_lt_u32 vcc, 3, v137
    s_cbranch_execz PLACED
    v_and_b32_sdwa v156, v119, v145 dst_sel:DWORD dst_unused:UNUSED_PAD src0_sel:BYTE_3 src1_sel:DWORD
    v_lshrrev_b32 v157, 18, v119
    v_lshl_or_b32 v157, v157, 9, v157
    v_and_b32 v158, s76, v119
    v_lshrrev_b64 v[154:155], v156, v[140:141]
    v_and_or_b32 v157, v157, s78, v147
    v_add_u16 v154, 12, v154
    v_add_u32 v158, v158, v134
    v_and_b32 v155, s77, v154
    v_add3_u32 v154, v154, v155, v144
    ds_write2st64_b32 v154, v157, v158 offset0:4 offset1:36
    v_cmpx_lt_u32 vcc, 4, v137
    s_cbranch_execz PLACED
    v_and_b32_sdwa v150, v120, v145 dst_sel:DWORD dst_unused:UNUSED_PAD src0_sel:BYTE_3 src1_sel:DWORD
    v_lshrrev_b32 v151, 18, v120
    v_lshl_or_b32 v151, v151, 9, v151
    v_and_b32 v152, s76, v120
    v_lshrrev_b64 v[148:149], v150, v[140:141]
    v_and_or_b32 v151, v151, s78, v147
    v_add_u16 v148, 16, v148
    v_add_u32 v152, v152, v134
    v_and_b32 v149, s77, v148
    v_add3_u32 v148, v148, v149, v144
    ds_write2st64_b32 v148, v151, v152 offset0:4 offset1:36
    v_cmpx_lt_u32 vcc, 5, v137
    s_cbranch_execz PLACED
    v_and_b32_sdwa v156, v121, v145 dst_sel:DWORD dst_unused:UNUSED_PAD src0_sel:BYTE_3 src1_sel:DWORD
    v_lshrrev_b32 v157, 18, v121
    v_lshl_or_b32 v157, v157, 9, v157
    v_and_b32 v158, s76, v121
    v_lshrrev_b64 v[154:155], v156, v[140:141]
    v_and_or_b32 v157, v157, s78, v147
    v_add_u16 v154, 20, v154
    v_add_u32 v158, v158, v134
    v_and_b32 v155, s77, v154
    v_add3_u32 v154, v154, v155, v144
    ds_write2st64_b32 v154, v157, v158 offset0:4 offset1:36
    v_cmpx_lt_u32 vcc, 6, v137
    s_cbranch_execz PLACED
    v_and_b32_sdwa v150, v122, v145 dst_sel:DWORD dst_unused:UNUSED_PAD src0_sel:BYTE_3 src1_sel:DWORD
    v_lshrrev_b32 v151, 18, v122
    v_lshl_or_b32 v151, v151, 9, v151
    v_and_b32 v152, s76, v122
    v_lshrrev_b64 v[148:149], v150, v[140:141]
    v_and_or_b32 v151, v151, s78, v147
    v_add_u16 v148, 24, v148
    v_add_u32 v152, v152, v134
    v_and_b32 v149, s77, v148
    v_add3_u32 v148, v148, v149, v144
    ds_write2st64_b32 v148, v151, v152 offset0:4 offset1:36
    v_cmpx_lt_u32 vcc, 7, v137
    s_cbranch_execz PLACED
    v_and_b32_sdwa v156, v123, v145 dst_sel:DWORD dst_unused:UNUSED_PAD src0_sel:BYTE_3 src1_sel:DWORD
    v_lshrrev_b32 v157, 18, v123
    v_lshl_or_b32 v157, v157, 9, v157
    v_and_b32 v158, s76, v123
    v_lshrrev_b64 v[154:155], v156, v[140:141]
    v_and_or_b32 v157, v157, s78, v147
    v_add_u16 v154, 28, v154
    v_add_u32 v158, v158, v134
    v_and_b32 v155, s77, v154
    v_add3_u32 v154, v154, v155, v144
    ds_write2st64_b32 v154, v157, v158 offset0:4 offset1:36
    v_cmpx_lt_u32 vcc, 8, v137
    s_cbranch_execz PLACED
    v_and_b32_sdwa v150, v124, v145 dst_sel:DWORD dst_unused:UNUSED_PAD src0_sel:BYTE_3 src1_sel:DWORD
    v_lshrrev_b32 v151, 18, v124
    v_lshl_or_b32 v151, v151, 9, v151
    v_and_b32 v152, s76, v124
    v_lshrrev_b64 v[148:149], v150, v[140:141]
    v_and_or_b32 v151, v151, s78, v147
    v_add_u16 v148, 32, v148
    v_add_u32 v152, v152, v134
    v_and_b32 v149, s77, v148
    v_add3_u32 v148, v148, v149, v144
    ds_write2st64_b32 v148, v151, v152 offset0:4 offset1:36
    v_cmpx_lt_u32 vcc, 9, v137
    s_cbranch_execz PLACED
    v_and_b32_sdwa v156, v125, v145 dst_sel:DWORD dst_unused:UNUSED_PAD src0_sel:BYTE_3 src1_sel:DWORD
    v_lshrrev_b32 v157, 18, v125
    v_lshl_or_b32 v157, v157, 9, v157
    v_and_b32 v158, s76, v125
    v_lshrrev_b64 v[154:155], v156, v[140:141]
    v_and_or_b32 v157, v157, s78, v147
    v_add_u16 v154, 36, v154
    v_add_u32 v158, v158, v134
    v_and_b32 v155, s77, v154
    v_add3_u32 v154, v154, v155, v144
    ds_write2st64_b32 v154, v157, v158 offset0:4 offset1:36
    v_cmpx_lt_u32 vcc, 10, v137
    s_cbranch_execz PLACED
    v_and_b32_sdwa v150, v126, v145 dst_sel:DWORD dst_unused:UNUSED_PAD src0_sel:BYTE_3 src1_sel:DWORD
    v_lshrrev_b32 v151, 18, v126
    v_lshl_or_b32 v151, v151, 9, v151
    v_and_b32 v152, s76, v126
    v_lshrrev_b64 v[148:149], v150, v[140:141]
    v_and_or_b32 v151, v151, s78, v147
    v_add_u16 v148, 40, v148
    v_add_u32 v152, v152, v134
    v_and_b32 v149, s77, v148
    v_add3_u32 v148, v148, v149, v144
    ds_write2st64_b32 v148, v151, v152 offset0:4 offset1:36
    v_cmpx_lt_u32 vcc, 11, v137
    s_cbranch_execz PLACED
    v_and_b32_sdwa v156, v127, v145 dst_sel:DWORD dst_unused:UNUSED_PAD src0_sel:BYTE_3 src1_sel:DWORD
    v_lshrrev_b32 v157, 18, v127
    v_lshl_or_b32 v157, v157, 9, v157
    v_and_b32 v158, s76, v127
    v_lshrrev_b64 v[154:155], v156, v[140:141]
    v_and_or_b32 v157, v157, s78, v147
    v_add_u16 v154, 44, v154
    v_add_u32 v158, v158, v134
    v_and_b32 v155, s77, v154
    v_add3_u32 v154, v154, v155, v144
    ds_write2st64_b32 v154, v157, v158 offset0:4 offset1:36
    v_cmpx_lt_u32 vcc, 12, v137
    s_cbranch_execz PLACED
    v_and_b32_sdwa v150, v128, v145 dst_sel:DWORD dst_unused:UNUSED_PAD src0_sel:BYTE_3 src1_sel:DWORD
    v_lshrrev_b32 v151, 18, v128
    v_lshl_or_b32 v151, v151, 9, v151
    v_and_b32 v152, s76, v128
    v_lshrrev_b64 v[148:149], v150, v[140:141]
    v_and_or_b32 v151, v151, s78, v147
    v_add_u16 v148, 48, v148
    v_add_u32 v152, v152, v134
    v_and_b32 v149, s77, v148
    v_add3_u32 v148, v148, v149, v144
    ds_write2st64_b32 v148, v151, v152 offset0:4 offset1:36
    v_cmpx_lt_u32 vcc, 13, v137
    s_cbranch_execz PLACED
    v_and_b32_sdwa v156, v129, v145 dst_sel:DWORD dst_unused:UNUSED_PAD src0_sel:BYTE_3 src1_sel:DWORD
    v_lshrrev_b32 v157, 18, v129
    v_lshl_or_b32 v157, v157, 9, v157
    v_and_b32 v158, s76, v129
    v_lshrrev_b64 v[154:155], v156, v[140:141]
    v_and_or_b32 v157, v157, s78, v147
    v_add_u16 v154, 52, v154
    v_add_u32 v158, v158, v134
    v_and_b32 v155, s77, v154
    v_add3_u32 v154, v154, v155, v144
    ds_write2st64_b32 v154, v157, v158 offset0:4 offset1:36
    v_cmpx_lt_u32 vcc, 14, v137
    s_cbranch_execz PLACED
    v_and_b32_sdwa v150, v130, v145 dst_sel:DWORD dst_unused:UNUSED_PAD src0_sel:BYTE_3 src1_sel:DWORD
    v_lshrrev_b32 v151, 18, v130
    v_lshl_or_b32 v151, v151, 9, v151
    v_and_b32 v152, s76, v130
    v_lshrrev_b64 v[148:149], v150, v[140:141]
    v_and_or_b32 v151, v151, s78, v147
    v_add_u16 v148, 56, v148
    v_add_u32 v152, v152, v134
    v_and_b32 v149, s77, v148
    v_add3_u32 v148, v148, v149, v144
    ds_write2st64_b32 v148, v151, v152 offset0:4 offset1:36
    v_cmpx_lt_u32 vcc, 15, v137
    s_cbranch_execz PLACED
    v_and_b32_sdwa v156, v131, v145 dst_sel:DWORD dst_unused:UNUSED_PAD src0_sel:BYTE_3 src1_sel:DWORD
    v_lshrrev_b32 v157, 18, v131
    v_lshl_or_b32 v157, v157, 9, v157
    v_and_b32 v158, s76, v131
    v_lshrrev_b64 v[154:155], v156, v[140:141]
    v_and_or_b32 v157, v157, s78, v147
    v_add_u16 v154, 60, v154
    v_add_u32 v158, v158, v134
    v_and_b32 v155, s77, v154
    v_add3_u32 v154, v154, v155, v144
    ds_write2st64_b32 v154, v157, v158 offset0:4 offset1:36
    v_cmpx_lt_u32 vcc, 16, v137
    s_cbranch_execz PLACED
    v_subrev_u32 v137, 16, v137
    v_add_u32 v136, 64, v136
    v_add_u32 v140, 0x00400040, v140
    v_add_u32 v141, 0x00400040, v141
    buffer_load_dwordx4 v[116:119], v136, s[16:19], 0 offen offset:0 sc1
    buffer_load_dwordx4 v[120:123], v136, s[16:19], 0 offen offset:16 sc1
    buffer_load_dwordx4 v[124:127], v136, s[16:19], 0 offen offset:32 sc1
    buffer_load_dwordx4 v[128:131], v136, s[16:19], 0 offen offset:48 sc1
    s_branch PLACE
PLACED:
    s_mov_b64 exec, -1
    s_waitcnt lgkmcnt(0)
    s_barrier
    s_cmp_lt_i32 s61, 1
    s_cbranch_scc1 NOTILE
    ds_read_b32 v16, v1 offset:0
    ds_read_b32 v18, v1 offset:128
    s_waitcnt lgkmcnt(0)
    v_mfma_f32_32x32x8_bf16 v[116:131], v[16:17], v[164:165], 0
    v_mfma_f32_32x32x8_bf16 v[132:147], v[18:19], v[164:165], 0
    s_nop 15
    s_nop 3
    buffer_load_dword v116, v116, s[20:23], 0 offen sc1
    buffer_load_dword v117, v117, s[20:23], 0 offen sc1
    buffer_load_dword v118, v118, s[20:23], 0 offen sc1
    buffer_load_dword v119, v119, s[20:23], 0 offen sc1
    buffer_load_dword v120, v120, s[20:23], 0 offen sc1
    buffer_load_dword v121, v121, s[20:23], 0 offen sc1
    buffer_load_dword v122, v122, s[20:23], 0 offen sc1
    buffer_load_dword v123, v123, s[20:23], 0 offen sc1
    buffer_load_dword v124, v124, s[20:23], 0 offen sc1
    buffer_load_dword v125, v125, s[20:23], 0 offen sc1
    buffer_load_dword v126, v126, s[20:23], 0 offen sc1
    buffer_load_dword v127, v127, s[20:23], 0 offen sc1
    buffer_load_dword v128, v128, s[20:23], 0 offen sc1
    buffer_load_dword v129, v129, s[20:23], 0 offen sc1
    buffer_load_dword v130, v130, s[20:23], 0 offen sc1
    buffer_load_dword v131, v131, s[20:23], 0 offen sc1
    buffer_load_dword v132, v132, s[20:23], 0 offen sc1
    buffer_load_dword v133, v133, s[20:23], 0 offen sc1
    buffer_load_dword v134, v134, s[20:23], 0 offen sc1
    buffer_load_dword v135, v135, s[20:23], 0 offen sc1
    buffer_load_dword v136, v136, s[20:23], 0 offen sc1
    buffer_load_dword v137, v137, s[20:23], 0 offen sc1
    buffer_load_dword v138, v138, s[20:23], 0 offen sc1
    buffer_load_dword v139, v139, s[20:23], 0 offen sc1
    buffer_load_dword v140, v140, s[20:23], 0 offen sc1
    buffer_load_dword v141, v141, s[20:23], 0 offen sc1
    buffer_load_dword v142, v142, s[20:23], 0 offen sc1
    buffer_load_dword v143, v143, s[20:23], 0 offen sc1
    buffer_load_dword v144, v144, s[20:23], 0 offen sc1
    buffer_load_dword v145, v145, s[20:23], 0 offen sc1
    buffer_load_dword v146, v146, s[20:23], 0 offen sc1
    buffer_load_dword v147, v147, s[20:23], 0 offen sc1
    ds_read_b32 v16, v1 offset:256
NOTILE:
    s_cmp_eq_u32 s58, 0
    s_cbranch_scc1 NOPACK
    s_mov_b32 s82, 0xbfb8aa3b
    s_mov_b32 s83, 0xbfb8aa3b
    v_cvt_pk_bf16_f32 v44, v100, v101
    v_cvt_pk_bf16_f32 v45, v102, v103
    v_cvt_pk_bf16_f32 v46, v104, v105
    v_cvt_pk_bf16_f32 v47, v106, v107
    v_cvt_pk_bf16_f32 v48, v108, v109
    v_cvt_pk_bf16_f32 v49, v110, v111
    v_cvt_pk_bf16_f32 v50, v112, v113
    v_cvt_pk_bf16_f32 v51, v114, v115
    v_pk_mul_f32 v[84:85], v[84:85], s[82:83]
    v_pk_mul_f32 v[86:87], v[86:87], s[82:83]
    v_pk_mul_f32 v[88:89], v[88:89], s[82:83]
    v_pk_mul_f32 v[90:91], v[90:91], s[82:83]
    v_pk_mul_f32 v[92:93], v[92:93], s[82:83]
    v_pk_mul_f32 v[94:95], v[94:95], s[82:83]
    v_pk_mul_f32 v[96:97], v[96:97], s[82:83]
    v_pk_mul_f32 v[98:99], v[98:99], s[82:83]
    v_cvt_pk_bf16_f32 v36, v84, v85
    v_cvt_pk_bf16_f32 v37, v86, v87
    v_cvt_pk_bf16_f32 v38, v88, v89
    v_cvt_pk_bf16_f32 v39, v90, v91
    v_cvt_pk_bf16_f32 v40, v92, v93
    v_cvt_pk_bf16_f32 v41, v94, v95
    v_cvt_pk_bf16_f32 v42, v96, v97
    v_cvt_pk_bf16_f32 v43, v98, v99
    v_mov_b64 v[52:53], 0
    v_mov_b64 v[54:55], 0
    v_mov_b64 v[56:57], 0
    v_mov_b64 v[58:59], 0
    v_mov_b64 v[60:61], 0
    v_mov_b64 v[62:63], 0
    v_mov_b64 v[64:65], 0
    v_mov_b64 v[66:67], 0
    v_mov_b64 v[68:69], 0
    v_mov_b64 v[70:71], 0
    v_mov_b64 v[72:73], 0
    v_mov_b64 v[74:75], 0
    v_mov_b64 v[76:77], 0
    v_mov_b64 v[78:79], 0
    v_mov_b64 v[80:81], 0
    v_mov_b64 v[82:83], 0
    v_bfe_u32 v8, v0, 5, 1
    v_bfe_u32 v9, v0, 3, 2
    s_lshl_b32 s80, s52, 2
    v_lshl_or_b32 v9, v8, 2, v9
    v_xor_b32 v9, s80, v9
    v_and_b32 v10, 7, v0
    v_lshlrev_b32 v10, 1, v10
    v_lshl_or_b32 v9, v9, 4, v10
    s_lshl_b32 s81, s53, 13
    s_add_u32 s81, s81, 148480
    v_lshl_add_u32 v8, v8, 10, s81
    v_add_u32 v20, v8, v9
    v_bfe_u32 v8, v0, 2, 4
    v_and_b32 v9, 3, v0
    v_or_b32 v10, s80, v9
    v_xor_b32 v10, v10, v8
    v_lshlrev_b32 v10, 4, v10
    v_lshl_add_u32 v10, v8, 8, v10
    v_add_u32 v21, s81, v10
    v_bfe_u32 v11, v0, 2, 2
    v_bfe_u32 v8, v0, 4, 1
    v_lshl_or_b32 v11, v8, 3, v11
    v_bfe_u32 v8, v0, 5, 1
    v_lshl_or_b32 v11, v8, 2, v11
    v_lshlrev_b32 v9, 4, v9
    v_lshl_or_b32 v11, v11, 18, v9
    s_lshl_b32 s80, s53, 17
    s_lshl_b32 s81, s2, 8
    s_add_u32 s80, s80, s81
    s_lshl_b32 s81, s52, 6
    s_add_u32 s80, s80, s81
    v_add_u32 v22, s80, v11
    v_add_u32 v23, 0x10000, v22
    s_mov_b32 s58, 0
NOPACK:
    s_cmp_lt_i32 s61, 1
    s_cbranch_scc1 RDONE
    v_mov_b64 v[100:101], 0
    v_mov_b64 v[102:103], 0
    v_mov_b64 v[104:105], 0
    v_mov_b64 v[106:107], 0
    v_mov_b64 v[108:109], 0
    v_mov_b64 v[110:111], 0
    v_mov_b64 v[112:113], 0
    v_mov_b64 v[114:115], 0
    s_cmp_le_u32 s62, s60
    s_cbranch_scc1 POLL_P
POLLED_P:
    ds_read_b128 v[8:11], v2
    ds_read_b128 v[12:15], v3
    s_waitcnt vmcnt(16) lgkmcnt(0)
    v_mfma_f32_32x32x16_bf16 v[84:99], v[8:11], v[32:35], v[116:131]
    v_mfma_f32_32x32x16_bf16 v[84:99], v[12:15], v[36:39], v[84:99]
    s_nop 11
    .p2align 6
LOOP:
    s_cmp_ge_u32 s60, s64
    s_cbranch_scc1 SKIP_0
    s_add_u32 s60, s60, 1
    s_setprio 3
    v_exp_f32 v84, v84
    v_exp_f32 v85, v85
    v_exp_f32 v86, v86
    v_exp_f32 v87, v87
    v_mfma_f32_32x32x8_bf16 v[148:163], v[16:17], v[164:165], 0
    v_exp_f32 v88, v88
    v_exp_f32 v89, v89
    v_exp_f32 v90, v90
    v_exp_f32 v91, v91
    v_smfmac_f32_32x32x32_bf16 v[52:67], v[24:27], v[100:107], v4
    v_exp_f32 v92, v92
    v_exp_f32 v93, v93
    v_exp_f32 v94, v94
    v_exp_f32 v95, v95
    v_smfmac_f32_32x32x32_bf16 v[52:67], v[28:31], v[108:115], v4
    v_exp_f32 v96, v96
    v_exp_f32 v97, v97
    v_exp_f32 v98, v98
    v_exp_f32 v99, v99
    s_cmp_ge_u32 s60, s66
    s_cbranch_scc1 NOG_0
    buffer_load_dword v148, v148, s[20:23], 0 offen sc1
    buffer_load_dword v149, v149, s[20:23], 0 offen sc1
    buffer_load_dword v150, v150, s[20:23], 0 offen sc1
    buffer_load_dword v151, v151, s[20:23], 0 offen sc1
    buffer_load_dword v152, v152, s[20:23], 0 offen sc1
    buffer_load_dword v153, v153, s[20:23], 0 offen sc1
    buffer_load_dword v154, v154, s[20:23], 0 offen sc1
    buffer_load_dword v155, v155, s[20:23], 0 offen sc1
    buffer_load_dword v156, v156, s[20:23], 0 offen sc1
    buffer_load_dword v157, v157, s[20:23], 0 offen sc1
    buffer_load_dword v158, v158, s[20:23], 0 offen sc1
    buffer_load_dword v159, v159, s[20:23], 0 offen sc1
    buffer_load_dword v160, v160, s[20:23], 0 offen sc1
    buffer_load_dword v161, v161, s[20:23], 0 offen sc1
    buffer_load_dword v162, v162, s[20:23], 0 offen sc1
    buffer_load_dword v163, v163, s[20:23], 0 offen sc1
NOGD_0:
    s_cmp_le_u32 s62, s60
    s_cbranch_scc1 POLL_0
POLLED_0:
    ds_read_b32 v16, v1 offset:384
    ds_read_b32 v166, v7 offset:96
    ds_read_b128 v[8:11], v2 offset:1024
    ds_read_b128 v[12:15], v3 offset:1024
    s_setprio 2
    ds_read_b64_tr_b16 v[24:25], v5 offset:0
    ds_read_b64_tr_b16 v[26:27], v5 offset:128
    ds_read_b64_tr_b16 v[28:29], v5 offset:512
    ds_read_b64_tr_b16 v[30:31], v5 offset:640
    v_pk_add_f32 v[84:85], v[84:85], 1.0 op_sel_hi:[1,0]
    v_pk_add_f32 v[86:87], v[86:87], 1.0 op_sel_hi:[1,0]
    v_pk_add_f32 v[88:89], v[88:89], 1.0 op_sel_hi:[1,0]
    v_pk_add_f32 v[90:91], v[90:91], 1.0 op_sel_hi:[1,0]
    v_pk_add_f32 v[92:93], v[92:93], 1.0 op_sel_hi:[1,0]
    v_pk_add_f32 v[94:95], v[94:95], 1.0 op_sel_hi:[1,0]
    v_pk_add_f32 v[96:97], v[96:97], 1.0 op_sel_hi:[1,0]
    v_pk_add_f32 v[98:99], v[98:99], 1.0 op_sel_hi:[1,0]
    v_lshlrev_b64 v[116:117], 16, v[116:117]
    v_lshlrev_b64 v[118:119], 16, v[118:119]
    v_lshlrev_b64 v[120:121], 16, v[120:121]
    v_lshlrev_b64 v[122:123], 16, v[122:123]
    v_lshlrev_b64 v[124:125], 16, v[124:125]
    v_lshlrev_b64 v[126:127], 16, v[126:127]
    v_lshlrev_b64 v[128:129], 16, v[128:129]
    v_lshlrev_b64 v[130:131], 16, v[130:131]
    s_setprio 1
    v_rcp_f32 v84, v84
    v_rcp_f32 v85, v85
    v_rcp_f32 v86, v86
    v_rcp_f32 v87, v87
    s_waitcnt vmcnt(16) lgkmcnt(4)
    v_mfma_f32_32x32x16_bf16 v[100:115], v[8:11], v[32:35], v[132:147]
    v_rcp_f32 v88, v88
    v_rcp_f32 v89, v89
    v_rcp_f32 v90, v90
    v_rcp_f32 v91, v91
    v_pk_mul_f32 v[116:117], v[116:117], v[84:85]
    v_pk_mul_f32 v[118:119], v[118:119], v[86:87]
    v_pk_mul_f32 v[120:121], v[120:121], v[88:89]
    v_pk_mul_f32 v[122:123], v[122:123], v[90:91]
    v_mfma_f32_32x32x16_bf16 v[100:115], v[12:15], v[40:43], v[100:115]
    s_setprio 0
    v_rcp_f32 v92, v92
    v_rcp_f32 v93, v93
    v_rcp_f32 v94, v94
    v_rcp_f32 v95, v95
    s_waitcnt lgkmcnt(0)
    v_smfmac_f32_32x32x32_bf16 v[68:83], v[24:27], v[116:123], v4
    v_rcp_f32 v96, v96
    v_rcp_f32 v97, v97
    v_rcp_f32 v98, v98
    v_rcp_f32 v99, v99
    v_pk_mul_f32 v[124:125], v[124:125], v[92:93]
    v_pk_mul_f32 v[126:127], v[126:127], v[94:95]
    v_pk_mul_f32 v[128:129], v[128:129], v[96:97]
    v_pk_mul_f32 v[130:131], v[130:131], v[98:99]
    s_nop 0
    s_cmp_ge_u32 s60, s61
    v_smfmac_f32_32x32x32_bf16 v[68:83], v[28:31], v[124:131], v4
    s_cbranch_scc1 DRAIN_0
NEXT_0:
    s_cmp_ge_u32 s60, s65
    s_cbranch_scc1 SKIP_1
    s_add_u32 s60, s60, 1
    s_setprio 3
    v_exp_f32 v100, v100
    v_exp_f32 v101, v101
    v_exp_f32 v102, v102
    v_exp_f32 v103, v103
    v_mfma_f32_32x32x8_bf16 v[116:131], v[16:17], v[164:165], 0
    v_exp_f32 v104, v104
    v_exp_f32 v105, v105
    v_exp_f32 v106, v106
    v_exp_f32 v107, v107
    v_smfmac_f32_32x32x32_bf16 v[52:67], v[24:27], v[84:91], v4
    v_exp_f32 v108, v108
    v_exp_f32 v109, v109
    v_exp_f32 v110, v110
    v_exp_f32 v111, v111
    v_smfmac_f32_32x32x32_bf16 v[52:67], v[28:31], v[92:99], v4
    v_exp_f32 v112, v112
    v_exp_f32 v113, v113
    v_exp_f32 v114, v114
    v_exp_f32 v115, v115
    v_readfirstlane_b32 s62, v166
    s_cmp_ge_u32 s60, s67
    s_cbranch_scc1 NOG_1
    buffer_load_dword v116, v116, s[20:23], 0 offen sc1
    buffer_load_dword v117, v117, s[20:23], 0 offen sc1
    buffer_load_dword v118, v118, s[20:23], 0 offen sc1
    buffer_load_dword v119, v119, s[20:23], 0 offen sc1
    buffer_load_dword v120, v120, s[20:23], 0 offen sc1
    buffer_load_dword v121, v121, s[20:23], 0 offen sc1
    buffer_load_dword v122, v122, s[20:23], 0 offen sc1
    buffer_load_dword v123, v123, s[20:23], 0 offen sc1
    buffer_load_dword v124, v124, s[20:23], 0 offen sc1
    buffer_load_dword v125, v125, s[20:23], 0 offen sc1
    buffer_load_dword v126, v126, s[20:23], 0 offen sc1
    buffer_load_dword v127, v127, s[20:23], 0 offen sc1
    buffer_load_dword v128, v128, s[20:23], 0 offen sc1
    buffer_load_dword v129, v129, s[20:23], 0 offen sc1
    buffer_load_dword v130, v130, s[20:23], 0 offen sc1
    buffer_load_dword v131, v131, s[20:23], 0 offen sc1
NOGD_1:
    s_mov_b64 exec, 1
    ds_inc_u32 v7, v2 offset:100
    s_mov_b64 exec, -1
    s_cmp_le_u32 s62, s60
    s_cbranch_scc1 POLL_1
POLLED_1:
    ds_read_b32 v16, v1 offset:512
    ds_read_b128 v[8:11], v2 offset:2048
    ds_read_b128 v[12:15], v3 offset:2048
    s_setprio 2
    ds_read_b64_tr_b16 v[24:25], v6 offset:1024
    ds_read_b64_tr_b16 v[26:27], v6 offset:1152
    ds_read_b64_tr_b16 v[28:29], v6 offset:1536
    ds_read_b64_tr_b16 v[30:31], v6 offset:1664
    v_pk_add_f32 v[100:101], v[100:101], 1.0 op_sel_hi:[1,0]
    v_pk_add_f32 v[102:103], v[102:103], 1.0 op_sel_hi:[1,0]
    v_pk_add_f32 v[104:105], v[104:105], 1.0 op_sel_hi:[1,0]
    v_pk_add_f32 v[106:107], v[106:107], 1.0 op_sel_hi:[1,0]
    v_pk_add_f32 v[108:109], v[108:109], 1.0 op_sel_hi:[1,0]
    v_pk_add_f32 v[110:111], v[110:111], 1.0 op_sel_hi:[1,0]
    v_pk_add_f32 v[112:113], v[112:113], 1.0 op_sel_hi:[1,0]
    v_pk_add_f32 v[114:115], v[114:115], 1.0 op_sel_hi:[1,0]
    v_lshlrev_b64 v[132:133], 16, v[132:133]
    v_lshlrev_b64 v[134:135], 16, v[134:135]
    v_lshlrev_b64 v[136:137], 16, v[136:137]
    v_lshlrev_b64 v[138:139], 16, v[138:139]
    v_lshlrev_b64 v[140:141], 16, v[140:141]
    v_lshlrev_b64 v[142:143], 16, v[142:143]
    v_lshlrev_b64 v[144:145], 16, v[144:145]
    v_lshlrev_b64 v[146:147], 16, v[146:147]
    s_setprio 1
    v_rcp_f32 v100, v100
    v_rcp_f32 v101, v101
    v_rcp_f32 v102, v102
    v_rcp_f32 v103, v103
    s_waitcnt vmcnt(16) lgkmcnt(4)
    v_mfma_f32_32x32x16_bf16 v[84:99], v[8:11], v[32:35], v[148:163]
    v_rcp_f32 v104, v104
    v_rcp_f32 v105, v105
    v_rcp_f32 v106, v106
    v_rcp_f32 v107, v107
    v_pk_mul_f32 v[132:133], v[132:133], v[100:101]
    v_pk_mul_f32 v[134:135], v[134:135], v[102:103]
    v_pk_mul_f32 v[136:137], v[136:137], v[104:105]
    v_pk_mul_f32 v[138:139], v[138:139], v[106:107]
    v_mfma_f32_32x32x16_bf16 v[84:99], v[12:15], v[36:39], v[84:99]
    s_setprio 0
    v_rcp_f32 v108, v108
    v_rcp_f32 v109, v109
    v_rcp_f32 v110, v110
    v_rcp_f32 v111, v111
    s_waitcnt lgkmcnt(0)
    v_smfmac_f32_32x32x32_bf16 v[68:83], v[24:27], v[132:139], v4
    v_rcp_f32 v112, v112
    v_rcp_f32 v113, v113
    v_rcp_f32 v114, v114
    v_rcp_f32 v115, v115
    v_pk_mul_f32 v[140:141], v[140:141], v[108:109]
    v_pk_mul_f32 v[142:143], v[142:143], v[110:111]
    v_pk_mul_f32 v[144:145], v[144:145], v[112:113]
    v_pk_mul_f32 v[146:147], v[146:147], v[114:115]
    s_nop 0
    s_cmp_ge_u32 s60, s61
    v_smfmac_f32_32x32x32_bf16 v[68:83], v[28:31], v[140:147], v4
    s_cbranch_scc1 DRAIN_1
NEXT_1:
    s_cmp_ge_u32 s60, s64
    s_cbranch_scc1 SKIP_2
    s_add_u32 s60, s60, 1
    s_setprio 3
    v_exp_f32 v84, v84
    v_exp_f32 v85, v85
    v_exp_f32 v86, v86
    v_exp_f32 v87, v87
    v_mfma_f32_32x32x8_bf16 v[132:147], v[16:17], v[164:165], 0
    v_exp_f32 v88, v88
    v_exp_f32 v89, v89
    v_exp_f32 v90, v90
    v_exp_f32 v91, v91
    v_smfmac_f32_32x32x32_bf16 v[52:67], v[24:27], v[100:107], v4
    v_exp_f32 v92, v92
    v_exp_f32 v93, v93
    v_exp_f32 v94, v94
    v_exp_f32 v95, v95
    v_smfmac_f32_32x32x32_bf16 v[52:67], v[28:31], v[108:115], v4
    v_exp_f32 v96, v96
    v_exp_f32 v97, v97
    v_exp_f32 v98, v98
    v_exp_f32 v99, v99
    s_cmp_ge_u32 s60, s66
    s_cbranch_scc1 NOG_2
    buffer_load_dword v132, v132, s[20:23], 0 offen sc1
    buffer_load_dword v133, v133, s[20:23], 0 offen sc1
    buffer_load_dword v134, v134, s[20:23], 0 offen sc1
    buffer_load_dword v135, v135, s[20:23], 0 offen sc1
    buffer_load_dword v136, v136, s[20:23], 0 offen sc1
    buffer_load_dword v137, v137, s[20:23], 0 offen sc1
    buffer_load_dword v138, v138, s[20:23], 0 offen sc1
    buffer_load_dword v139, v139, s[20:23], 0 offen sc1
    buffer_load_dword v140, v140, s[20:23], 0 offen sc1
    buffer_load_dword v141, v141, s[20:23], 0 offen sc1
    buffer_load_dword v142, v142, s[20:23], 0 offen sc1
    buffer_load_dword v143, v143, s[20:23], 0 offen sc1
    buffer_load_dword v144, v144, s[20:23], 0 offen sc1
    buffer_load_dword v145, v145, s[20:23], 0 offen sc1
    buffer_load_dword v146, v146, s[20:23], 0 offen sc1
    buffer_load_dword v147, v147, s[20:23], 0 offen sc1
NOGD_2:
    s_cmp_le_u32 s62, s60
    s_cbranch_scc1 POLL_2
POLLED_2:
    ds_read_b32 v16, v1 offset:640
    ds_read_b32 v166, v7 offset:96
    ds_read_b128 v[8:11], v2 offset:3072
    ds_read_b128 v[12:15], v3 offset:3072
    s_setprio 2
    ds_read_b64_tr_b16 v[24:25], v5 offset:2048
    ds_read_b64_tr_b16 v[26:27], v5 offset:2176
    ds_read_b64_tr_b16 v[28:29], v5 offset:2560
    ds_read_b64_tr_b16 v[30:31], v5 offset:2688
    v_pk_add_f32 v[84:85], v[84:85], 1.0 op_sel_hi:[1,0]
    v_pk_add_f32 v[86:87], v[86:87], 1.0 op_sel_hi:[1,0]
    v_pk_add_f32 v[88:89], v[88:89], 1.0 op_sel_hi:[1,0]
    v_pk_add_f32 v[90:91], v[90:91], 1.0 op_sel_hi:[1,0]
    v_pk_add_f32 v[92:93], v[92:93], 1.0 op_sel_hi:[1,0]
    v_pk_add_f32 v[94:95], v[94:95], 1.0 op_sel_hi:[1,0]
    v_pk_add_f32 v[96:97], v[96:97], 1.0 op_sel_hi:[1,0]
    v_pk_add_f32 v[98:99], v[98:99], 1.0 op_sel_hi:[1,0]
    v_lshlrev_b64 v[148:149], 16, v[148:149]
    v_lshlrev_b64 v[150:151], 16, v[150:151]
    v_lshlrev_b64 v[152:153], 16, v[152:153]
    v_lshlrev_b64 v[154:155], 16, v[154:155]
    v_lshlrev_b64 v[156:157], 16, v[156:157]
    v_lshlrev_b64 v[158:159], 16, v[158:159]
    v_lshlrev_b64 v[160:161], 16, v[160:161]
    v_lshlrev_b64 v[162:163], 16, v[162:163]
    s_setprio 1
    v_rcp_f32 v84, v84
    v_rcp_f32 v85, v85
    v_rcp_f32 v86, v86
    v_rcp_f32 v87, v87
    s_waitcnt vmcnt(16) lgkmcnt(4)
    v_mfma_f32_32x32x16_bf16 v[100:115], v[8:11], v[32:35], v[116:131]
    v_rcp_f32 v88, v88
    v_rcp_f32 v89, v89
    v_rcp_f32 v90, v90
    v_rcp_f32 v91, v91
    v_pk_mul_f32 v[148:149], v[148:149], v[84:85]
    v_pk_mul_f32 v[150:151], v[150:151], v[86:87]
    v_pk_mul_f32 v[152:153], v[152:153], v[88:89]
    v_pk_mul_f32 v[154:155], v[154:155], v[90:91]
    v_mfma_f32_32x32x16_bf16 v[100:115], v[12:15], v[40:43], v[100:115]
    s_setprio 0
    v_rcp_f32 v92, v92
    v_rcp_f32 v93, v93
    v_rcp_f32 v94, v94
    v_rcp_f32 v95, v95
    s_waitcnt lgkmcnt(0)
    v_smfmac_f32_32x32x32_bf16 v[68:83], v[24:27], v[148:155], v4
    v_rcp_f32 v96, v96
    v_rcp_f32 v97, v97
    v_rcp_f32 v98, v98
    v_rcp_f32 v99, v99
    v_pk_mul_f32 v[156:157], v[156:157], v[92:93]
    v_pk_mul_f32 v[158:159], v[158:159], v[94:95]
    v_pk_mul_f32 v[160:161], v[160:161], v[96:97]
    v_pk_mul_f32 v[162:163], v[162:163], v[98:99]
    s_nop 0
    s_cmp_ge_u32 s60, s61
    v_smfmac_f32_32x32x32_bf16 v[68:83], v[28:31], v[156:163], v4
    s_cbranch_scc1 DRAIN_0
NEXT_2:
    s_cmp_ge_u32 s60, s65
    s_cbranch_scc1 SKIP_3
    s_add_u32 s60, s60, 1
    s_setprio 3
    v_exp_f32 v100, v100
    v_exp_f32 v101, v101
    v_exp_f32 v102, v102
    v_exp_f32 v103, v103
    v_mfma_f32_32x32x8_bf16 v[148:163], v[16:17], v[164:165], 0
    v_exp_f32 v104, v104
    v_exp_f32 v105, v105
    v_exp_f32 v106, v106
    v_exp_f32 v107, v107
    v_smfmac_f32_32x32x32_bf16 v[52:67], v[24:27], v[84:91], v4
    v_exp_f32 v108, v108
    v_exp_f32 v109, v109
    v_exp_f32 v110, v110
    v_exp_f32 v111, v111
    v_smfmac_f32_32x32x32_bf16 v[52:67], v[28:31], v[92:99], v4
    v_exp_f32 v112, v112
    v_exp_f32 v113, v113
    v_exp_f32 v114, v114
    v_exp_f32 v115, v115
    v_readfirstlane_b32 s62, v166
    s_cmp_ge_u32 s60, s67
    s_cbranch_scc1 NOG_3
    buffer_load_dword v148, v148, s[20:23], 0 offen sc1
    buffer_load_dword v149, v149, s[20:23], 0 offen sc1
    buffer_load_dword v150, v150, s[20:23], 0 offen sc1
    buffer_load_dword v151, v151, s[20:23], 0 offen sc1
    buffer_load_dword v152, v152, s[20:23], 0 offen sc1
    buffer_load_dword v153, v153, s[20:23], 0 offen sc1
    buffer_load_dword v154, v154, s[20:23], 0 offen sc1
    buffer_load_dword v155, v155, s[20:23], 0 offen sc1
    buffer_load_dword v156, v156, s[20:23], 0 offen sc1
    buffer_load_dword v157, v157, s[20:23], 0 offen sc1
    buffer_load_dword v158, v158, s[20:23], 0 offen sc1
    buffer_load_dword v159, v159, s[20:23], 0 offen sc1
    buffer_load_dword v160, v160, s[20:23], 0 offen sc1
    buffer_load_dword v161, v161, s[20:23], 0 offen sc1
    buffer_load_dword v162, v162, s[20:23], 0 offen sc1
    buffer_load_dword v163, v163, s[20:23], 0 offen sc1
NOGD_3:
    s_mov_b64 exec, 1
    ds_inc_u32 v7, v2 offset:100
    s_mov_b64 exec, -1
    s_cmp_le_u32 s62, s60
    s_cbranch_scc1 POLL_3
POLLED_3:
    ds_read_b32 v16, v1 offset:768
    ds_read_b128 v[8:11], v2 offset:4096
    ds_read_b128 v[12:15], v3 offset:4096
    s_setprio 2
    ds_read_b64_tr_b16 v[24:25], v6 offset:3072
    ds_read_b64_tr_b16 v[26:27], v6 offset:3200
    ds_read_b64_tr_b16 v[28:29], v6 offset:3584
    ds_read_b64_tr_b16 v[30:31], v6 offset:3712
    v_pk_add_f32 v[100:101], v[100:101], 1.0 op_sel_hi:[1,0]
    v_pk_add_f32 v[102:103], v[102:103], 1.0 op_sel_hi:[1,0]
    v_pk_add_f32 v[104:105], v[104:105], 1.0 op_sel_hi:[1,0]
    v_pk_add_f32 v[106:107], v[106:107], 1.0 op_sel_hi:[1,0]
    v_pk_add_f32 v[108:109], v[108:109], 1.0 op_sel_hi:[1,0]
    v_pk_add_f32 v[110:111], v[110:111], 1.0 op_sel_hi:[1,0]
    v_pk_add_f32 v[112:113], v[112:113], 1.0 op_sel_hi:[1,0]
    v_pk_add_f32 v[114:115], v[114:115], 1.0 op_sel_hi:[1,0]
    v_lshlrev_b64 v[116:117], 16, v[116:117]
    v_lshlrev_b64 v[118:119], 16, v[118:119]
    v_lshlrev_b64 v[120:121], 16, v[120:121]
    v_lshlrev_b64 v[122:123], 16, v[122:123]
    v_lshlrev_b64 v[124:125], 16, v[124:125]
    v_lshlrev_b64 v[126:127], 16, v[126:127]
    v_lshlrev_b64 v[128:129], 16, v[128:129]
    v_lshlrev_b64 v[130:131], 16, v[130:131]
    s_setprio 1
    v_rcp_f32 v100, v100
    v_rcp_f32 v101, v101
    v_rcp_f32 v102, v102
    v_rcp_f32 v103, v103
    s_waitcnt vmcnt(16) lgkmcnt(4)
    v_mfma_f32_32x32x16_bf16 v[84:99], v[8:11], v[32:35], v[132:147]
    v_rcp_f32 v104, v104
    v_rcp_f32 v105, v105
    v_rcp_f32 v106, v106
    v_rcp_f32 v107, v107
    v_pk_mul_f32 v[116:117], v[116:117], v[100:101]
    v_pk_mul_f32 v[118:119], v[118:119], v[102:103]
    v_pk_mul_f32 v[120:121], v[120:121], v[104:105]
    v_pk_mul_f32 v[122:123], v[122:123], v[106:107]
    v_mfma_f32_32x32x16_bf16 v[84:99], v[12:15], v[36:39], v[84:99]
    s_setprio 0
    v_rcp_f32 v108, v108
    v_rcp_f32 v109, v109
    v_rcp_f32 v110, v110
    v_rcp_f32 v111, v111
    s_waitcnt lgkmcnt(0)
    v_smfmac_f32_32x32x32_bf16 v[68:83], v[24:27], v[116:123], v4
    v_rcp_f32 v112, v112
    v_rcp_f32 v113, v113
    v_rcp_f32 v114, v114
    v_rcp_f32 v115, v115
    v_pk_mul_f32 v[124:125], v[124:125], v[108:109]
    v_pk_mul_f32 v[126:127], v[126:127], v[110:111]
    v_pk_mul_f32 v[128:129], v[128:129], v[112:113]
    v_pk_mul_f32 v[130:131], v[130:131], v[114:115]
    s_nop 0
    s_cmp_ge_u32 s60, s61
    v_smfmac_f32_32x32x32_bf16 v[68:83], v[28:31], v[124:131], v4
    s_cbranch_scc1 DRAIN_1
NEXT_3:
    s_cmp_ge_u32 s60, s64
    s_cbranch_scc1 SKIP_4
    s_add_u32 s60, s60, 1
    s_setprio 3
    v_exp_f32 v84, v84
    v_exp_f32 v85, v85
    v_exp_f32 v86, v86
    v_exp_f32 v87, v87
    v_mfma_f32_32x32x8_bf16 v[116:131], v[16:17], v[164:165], 0
    v_exp_f32 v88, v88
    v_exp_f32 v89, v89
    v_exp_f32 v90, v90
    v_exp_f32 v91, v91
    v_smfmac_f32_32x32x32_bf16 v[52:67], v[24:27], v[100:107], v4
    v_exp_f32 v92, v92
    v_exp_f32 v93, v93
    v_exp_f32 v94, v94
    v_exp_f32 v95, v95
    v_smfmac_f32_32x32x32_bf16 v[52:67], v[28:31], v[108:115], v4
    v_exp_f32 v96, v96
    v_exp_f32 v97, v97
    v_exp_f32 v98, v98
    v_exp_f32 v99, v99
    s_cmp_ge_u32 s60, s66
    s_cbranch_scc1 NOG_4
    buffer_load_dword v116, v116, s[20:23], 0 offen sc1
    buffer_load_dword v117, v117, s[20:23], 0 offen sc1
    buffer_load_dword v118, v118, s[20:23], 0 offen sc1
    buffer_load_dword v119, v119, s[20:23], 0 offen sc1
    buffer_load_dword v120, v120, s[20:23], 0 offen sc1
    buffer_load_dword v121, v121, s[20:23], 0 offen sc1
    buffer_load_dword v122, v122, s[20:23], 0 offen sc1
    buffer_load_dword v123, v123, s[20:23], 0 offen sc1
    buffer_load_dword v124, v124, s[20:23], 0 offen sc1
    buffer_load_dword v125, v125, s[20:23], 0 offen sc1
    buffer_load_dword v126, v126, s[20:23], 0 offen sc1
    buffer_load_dword v127, v127, s[20:23], 0 offen sc1
    buffer_load_dword v128, v128, s[20:23], 0 offen sc1
    buffer_load_dword v129, v129, s[20:23], 0 offen sc1
    buffer_load_dword v130, v130, s[20:23], 0 offen sc1
    buffer_load_dword v131, v131, s[20:23], 0 offen sc1
NOGD_4:
    s_cmp_le_u32 s62, s60
    s_cbranch_scc1 POLL_4
POLLED_4:
    ds_read_b32 v16, v1 offset:896
    ds_read_b32 v166, v7 offset:96
    ds_read_b128 v[8:11], v2 offset:5120
    ds_read_b128 v[12:15], v3 offset:5120
    s_setprio 2
    ds_read_b64_tr_b16 v[24:25], v5 offset:4096
    ds_read_b64_tr_b16 v[26:27], v5 offset:4224
    ds_read_b64_tr_b16 v[28:29], v5 offset:4608
    ds_read_b64_tr_b16 v[30:31], v5 offset:4736
    v_pk_add_f32 v[84:85], v[84:85], 1.0 op_sel_hi:[1,0]
    v_pk_add_f32 v[86:87], v[86:87], 1.0 op_sel_hi:[1,0]
    v_pk_add_f32 v[88:89], v[88:89], 1.0 op_sel_hi:[1,0]
    v_pk_add_f32 v[90:91], v[90:91], 1.0 op_sel_hi:[1,0]
    v_pk_add_f32 v[92:93], v[92:93], 1.0 op_sel_hi:[1,0]
    v_pk_add_f32 v[94:95], v[94:95], 1.0 op_sel_hi:[1,0]
    v_pk_add_f32 v[96:97], v[96:97], 1.0 op_sel_hi:[1,0]
    v_pk_add_f32 v[98:99], v[98:99], 1.0 op_sel_hi:[1,0]
    v_lshlrev_b64 v[132:133], 16, v[132:133]
    v_lshlrev_b64 v[134:135], 16, v[134:135]
    v_lshlrev_b64 v[136:137], 16, v[136:137]
    v_lshlrev_b64 v[138:139], 16, v[138:139]
    v_lshlrev_b64 v[140:141], 16, v[140:141]
    v_lshlrev_b64 v[142:143], 16, v[142:143]
    v_lshlrev_b64 v[144:145], 16, v[144:145]
    v_lshlrev_b64 v[146:147], 16, v[146:147]
    s_setprio 1
    v_rcp_f32 v84, v84
    v_rcp_f32 v85, v85
    v_rcp_f32 v86, v86
    v_rcp_f32 v87, v87
    s_waitcnt vmcnt(16) lgkmcnt(4)
    v_mfma_f32_32x32x16_bf16 v[100:115], v[8:11], v[32:35], v[148:163]
    v_rcp_f32 v88, v88
    v_rcp_f32 v89, v89
    v_rcp_f32 v90, v90
    v_rcp_f32 v91, v91
    v_pk_mul_f32 v[132:133], v[132:133], v[84:85]
    v_pk_mul_f32 v[134:135], v[134:135], v[86:87]
    v_pk_mul_f32 v[136:137], v[136:137], v[88:89]
    v_pk_mul_f32 v[138:139], v[138:139], v[90:91]
    v_mfma_f32_32x32x16_bf16 v[100:115], v[12:15], v[40:43], v[100:115]
    s_setprio 0
    v_rcp_f32 v92, v92
    v_rcp_f32 v93, v93
    v_rcp_f32 v94, v94
    v_rcp_f32 v95, v95
    s_waitcnt lgkmcnt(0)
    v_smfmac_f32_32x32x32_bf16 v[68:83], v[24:27], v[132:139], v4
    v_rcp_f32 v96, v96
    v_rcp_f32 v97, v97
    v_rcp_f32 v98, v98
    v_rcp_f32 v99, v99
    v_pk_mul_f32 v[140:141], v[140:141], v[92:93]
    v_pk_mul_f32 v[142:143], v[142:143], v[94:95]
    v_pk_mul_f32 v[144:145], v[144:145], v[96:97]
    v_pk_mul_f32 v[146:147], v[146:147], v[98:99]
    s_nop 0
    s_cmp_ge_u32 s60, s61
    v_smfmac_f32_32x32x32_bf16 v[68:83], v[28:31], v[140:147], v4
    s_cbranch_scc1 DRAIN_0
NEXT_4:
    s_cmp_ge_u32 s60, s65
    s_cbranch_scc1 SKIP_5
    s_add_u32 s60, s60, 1
    s_setprio 3
    v_exp_f32 v100, v100
    v_exp_f32 v101, v101
    v_exp_f32 v102, v102
    v_exp_f32 v103, v103
    v_mfma_f32_32x32x8_bf16 v[132:147], v[16:17], v[164:165], 0
    v_exp_f32 v104, v104
    v_exp_f32 v105, v105
    v_exp_f32 v106, v106
    v_exp_f32 v107, v107
    v_smfmac_f32_32x32x32_bf16 v[52:67], v[24:27], v[84:91], v4
    v_exp_f32 v108, v108
    v_exp_f32 v109, v109
    v_exp_f32 v110, v110
    v_exp_f32 v111, v111
    v_smfmac_f32_32x32x32_bf16 v[52:67], v[28:31], v[92:99], v4
    v_exp_f32 v112, v112
    v_exp_f32 v113, v113
    v_exp_f32 v114, v114
    v_exp_f32 v115, v115
    v_readfirstlane_b32 s62, v166
    s_cmp_ge_u32 s60, s67
    s_cbranch_scc1 NOG_5
    buffer_load_dword v132, v132, s[20:23], 0 offen sc1
    buffer_load_dword v133, v133, s[20:23], 0 offen sc1
    buffer_load_dword v134, v134, s[20:23], 0 offen sc1
    buffer_load_dword v135, v135, s[20:23], 0 offen sc1
    buffer_load_dword v136, v136, s[20:23], 0 offen sc1
    buffer_load_dword v137, v137, s[20:23], 0 offen sc1
    buffer_load_dword v138, v138, s[20:23], 0 offen sc1
    buffer_load_dword v139, v139, s[20:23], 0 offen sc1
    buffer_load_dword v140, v140, s[20:23], 0 offen sc1
    buffer_load_dword v141, v141, s[20:23], 0 offen sc1
    buffer_load_dword v142, v142, s[20:23], 0 offen sc1
    buffer_load_dword v143, v143, s[20:23], 0 offen sc1
    buffer_load_dword v144, v144, s[20:23], 0 offen sc1
    buffer_load_dword v145, v145, s[20:23], 0 offen sc1
    buffer_load_dword v146, v146, s[20:23], 0 offen sc1
    buffer_load_dword v147, v147, s[20:23], 0 offen sc1
NOGD_5:
    s_mov_b64 exec, 1
    ds_inc_u32 v7, v2 offset:100
    s_mov_b64 exec, -1
    s_cmp_le_u32 s62, s60
    s_cbranch_scc1 POLL_5
POLLED_5:
    ds_read_b32 v16, v1 offset:1024
    ds_read_b128 v[8:11], v2 offset:6144
    ds_read_b128 v[12:15], v3 offset:6144
    s_setprio 2
    ds_read_b64_tr_b16 v[24:25], v6 offset:5120
    ds_read_b64_tr_b16 v[26:27], v6 offset:5248
    ds_read_b64_tr_b16 v[28:29], v6 offset:5632
    ds_read_b64_tr_b16 v[30:31], v6 offset:5760
    v_pk_add_f32 v[100:101], v[100:101], 1.0 op_sel_hi:[1,0]
    v_pk_add_f32 v[102:103], v[102:103], 1.0 op_sel_hi:[1,0]
    v_pk_add_f32 v[104:105], v[104:105], 1.0 op_sel_hi:[1,0]
    v_pk_add_f32 v[106:107], v[106:107], 1.0 op_sel_hi:[1,0]
    v_pk_add_f32 v[108:109], v[108:109], 1.0 op_sel_hi:[1,0]
    v_pk_add_f32 v[110:111], v[110:111], 1.0 op_sel_hi:[1,0]
    v_pk_add_f32 v[112:113], v[112:113], 1.0 op_sel_hi:[1,0]
    v_pk_add_f32 v[114:115], v[114:115], 1.0 op_sel_hi:[1,0]
    v_lshlrev_b64 v[148:149], 16, v[148:149]
    v_lshlrev_b64 v[150:151], 16, v[150:151]
    v_lshlrev_b64 v[152:153], 16, v[152:153]
    v_lshlrev_b64 v[154:155], 16, v[154:155]
    v_lshlrev_b64 v[156:157], 16, v[156:157]
    v_lshlrev_b64 v[158:159], 16, v[158:159]
    v_lshlrev_b64 v[160:161], 16, v[160:161]
    v_lshlrev_b64 v[162:163], 16, v[162:163]
    s_setprio 1
    v_rcp_f32 v100, v100
    v_rcp_f32 v101, v101
    v_rcp_f32 v102, v102
    v_rcp_f32 v103, v103
    s_waitcnt vmcnt(16) lgkmcnt(4)
    v_mfma_f32_32x32x16_bf16 v[84:99], v[8:11], v[32:35], v[116:131]
    v_rcp_f32 v104, v104
    v_rcp_f32 v105, v105
    v_rcp_f32 v106, v106
    v_rcp_f32 v107, v107
    v_pk_mul_f32 v[148:149], v[148:149], v[100:101]
    v_pk_mul_f32 v[150:151], v[150:151], v[102:103]
    v_pk_mul_f32 v[152:153], v[152:153], v[104:105]
    v_pk_mul_f32 v[154:155], v[154:155], v[106:107]
    v_mfma_f32_32x32x16_bf16 v[84:99], v[12:15], v[36:39], v[84:99]
    s_setprio 0
    v_rcp_f32 v108, v108
    v_rcp_f32 v109, v109
    v_rcp_f32 v110, v110
    v_rcp_f32 v111, v111
    s_waitcnt lgkmcnt(0)
    v_smfmac_f32_32x32x32_bf16 v[68:83], v[24:27], v[148:155], v4
    v_rcp_f32 v112, v112
    v_rcp_f32 v113, v113
    v_rcp_f32 v114, v114
    v_rcp_f32 v115, v115
    v_pk_mul_f32 v[156:157], v[156:157], v[108:109]
    v_pk_mul_f32 v[158:159], v[158:159], v[110:111]
    v_pk_mul_f32 v[160:161], v[160:161], v[112:113]
    v_pk_mul_f32 v[162:163], v[162:163], v[114:115]
    s_nop 0
    s_cmp_ge_u32 s60, s61
    v_smfmac_f32_32x32x32_bf16 v[68:83], v[28:31], v[156:163], v4
    s_cbranch_scc1 DRAIN_1
NEXT_5:
    v_add_u32 v1, 768, v1
    v_add_u32 v2, 6144, v2
    v_add_u32 v3, 6144, v3
    v_add_u32 v5, 6144, v5
    v_add_u32 v6, 6144, v6
    s_branch LOOP
DRAIN_0:
    s_waitcnt lgkmcnt(0)
    v_smfmac_f32_32x32x32_bf16 v[52:67], v[24:27], v[84:91], v4
    v_smfmac_f32_32x32x32_bf16 v[52:67], v[28:31], v[92:99], v4
    s_branch RDONE
DRAIN_1:
    s_waitcnt lgkmcnt(0)
    v_smfmac_f32_32x32x32_bf16 v[52:67], v[24:27], v[100:107], v4
    v_smfmac_f32_32x32x32_bf16 v[52:67], v[28:31], v[108:115], v4
RDONE:
    v_mov_b32 v166, 16
    ds_add_u32 v7, v166 offset:100
    s_cmp_lg_u32 s54, 0
    s_cbranch_scc1 SLOWNEXT
EPI:
    v_mov_b64 v[100:101], 0
    v_mov_b64 v[102:103], 0
    v_mov_b64 v[104:105], 0
    v_mov_b64 v[106:107], 0
    v_mov_b64 v[108:109], 0
    v_mov_b64 v[110:111], 0
    v_mov_b64 v[112:113], 0
    v_mov_b64 v[114:115], 0
    v_xor_b32 v25, 16, v20
    v_xor_b32 v26, 32, v20
    v_xor_b32 v27, 48, v20
    v_xor_b32 v28, 128, v20
    v_xor_b32 v29, 144, v20
    v_xor_b32 v30, 160, v20
    v_xor_b32 v31, 176, v20
    ds_read_u16_d16_hi v100, v20 offset:0
    ds_read_u16_d16_hi v101, v25 offset:256
    ds_read_u16_d16_hi v102, v26 offset:512
    ds_read_u16_d16_hi v103, v27 offset:768
    ds_read_u16_d16_hi v104, v28 offset:2048
    ds_read_u16_d16_hi v105, v29 offset:2304
    ds_read_u16_d16_hi v106, v30 offset:2560
    ds_read_u16_d16_hi v107, v31 offset:2816
    ds_read_u16_d16_hi v108, v20 offset:4096
    ds_read_u16_d16_hi v109, v25 offset:4352
    ds_read_u16_d16_hi v110, v26 offset:4608
    ds_read_u16_d16_hi v111, v27 offset:4864
    ds_read_u16_d16_hi v112, v28 offset:6144
    ds_read_u16_d16_hi v113, v29 offset:6400
    ds_read_u16_d16_hi v114, v30 offset:6656
    ds_read_u16_d16_hi v115, v31 offset:6912
    s_mov_b32 s80, 0x358637bd
    s_mov_b32 s81, 0x358637bd
    v_pk_add_f32 v[52:53], v[52:53], s[80:81]
    v_pk_add_f32 v[54:55], v[54:55], s[80:81]
    v_pk_add_f32 v[56:57], v[56:57], s[80:81]
    v_pk_add_f32 v[58:59], v[58:59], s[80:81]
    v_pk_add_f32 v[60:61], v[60:61], s[80:81]
    v_pk_add_f32 v[62:63], v[62:63], s[80:81]
    v_pk_add_f32 v[64:65], v[64:65], s[80:81]
    v_pk_add_f32 v[66:67], v[66:67], s[80:81]
    v_rcp_f32 v52, v52
    v_rcp_f32 v53, v53
    v_rcp_f32 v54, v54
    v_rcp_f32 v55, v55
    v_rcp_f32 v56, v56
    v_rcp_f32 v57, v57
    v_rcp_f32 v58, v58
    v_rcp_f32 v59, v59
    v_rcp_f32 v60, v60
    v_rcp_f32 v61, v61
    v_rcp_f32 v62, v62
    v_rcp_f32 v63, v63
    v_rcp_f32 v64, v64
    v_rcp_f32 v65, v65
    v_rcp_f32 v66, v66
    v_rcp_f32 v67, v67
    v_lshlrev_b32 v84, 16, v44
    v_and_b32 v85, 0xffff0000, v44
    v_lshlrev_b32 v86, 16, v45
    v_and_b32 v87, 0xffff0000, v45
    v_lshlrev_b32 v88, 16, v46
    v_and_b32 v89, 0xffff0000, v46
    v_lshlrev_b32 v90, 16, v47
    v_and_b32 v91, 0xffff0000, v47
    v_lshlrev_b32 v92, 16, v48
    v_and_b32 v93, 0xffff0000, v48
    v_lshlrev_b32 v94, 16, v49
    v_and_b32 v95, 0xffff0000, v49
    v_lshlrev_b32 v96, 16, v50
    v_and_b32 v97, 0xffff0000, v50
    v_lshlrev_b32 v98, 16, v51
    v_and_b32 v99, 0xffff0000, v51
    v_pk_fma_f32 v[84:85], v[68:69], v[52:53], v[84:85]
    v_pk_fma_f32 v[86:87], v[70:71], v[54:55], v[86:87]
    v_pk_fma_f32 v[88:89], v[72:73], v[56:57], v[88:89]
    v_pk_fma_f32 v[90:91], v[74:75], v[58:59], v[90:91]
    v_pk_fma_f32 v[92:93], v[76:77], v[60:61], v[92:93]
    v_pk_fma_f32 v[94:95], v[78:79], v[62:63], v[94:95]
    v_pk_fma_f32 v[96:97], v[80:81], v[64:65], v[96:97]
    v_pk_fma_f32 v[98:99], v[82:83], v[66:67], v[98:99]
    v_max_f32 v84, 0, v84
    v_max_f32 v85, 0, v85
    v_max_f32 v86, 0, v86
    v_max_f32 v87, 0, v87
    v_max_f32 v88, 0, v88
    v_max_f32 v89, 0, v89
    v_max_f32 v90, 0, v90
    v_max_f32 v91, 0, v91
    v_max_f32 v92, 0, v92
    v_max_f32 v93, 0, v93
    v_max_f32 v94, 0, v94
    v_max_f32 v95, 0, v95
    v_max_f32 v96, 0, v96
    v_max_f32 v97, 0, v97
    v_max_f32 v98, 0, v98
    v_max_f32 v99, 0, v99
    s_waitcnt lgkmcnt(0)
    v_pk_add_f32 v[84:85], v[84:85], v[100:101]
    v_pk_add_f32 v[86:87], v[86:87], v[102:103]
    v_pk_add_f32 v[88:89], v[88:89], v[104:105]
    v_pk_add_f32 v[90:91], v[90:91], v[106:107]
    v_pk_add_f32 v[92:93], v[92:93], v[108:109]
    v_pk_add_f32 v[94:95], v[94:95], v[110:111]
    v_pk_add_f32 v[96:97], v[96:97], v[112:113]
    v_pk_add_f32 v[98:99], v[98:99], v[114:115]
    v_cvt_pk_bf16_f32 v100, v84, v85
    v_cvt_pk_bf16_f32 v101, v86, v87
    v_cvt_pk_bf16_f32 v102, v88, v89
    v_cvt_pk_bf16_f32 v103, v90, v91
    v_cvt_pk_bf16_f32 v104, v92, v93
    v_cvt_pk_bf16_f32 v105, v94, v95
    v_cvt_pk_bf16_f32 v106, v96, v97
    v_cvt_pk_bf16_f32 v107, v98, v99
    ds_write_b16 v20, v100 offset:0
    ds_write_b16_d16_hi v25, v100 offset:256
    ds_write_b16 v26, v101 offset:512
    ds_write_b16_d16_hi v27, v101 offset:768
    ds_write_b16 v28, v102 offset:2048
    ds_write_b16_d16_hi v29, v102 offset:2304
    ds_write_b16 v30, v103 offset:2560
    ds_write_b16_d16_hi v31, v103 offset:2816
    ds_write_b16 v20, v104 offset:4096
    ds_write_b16_d16_hi v25, v104 offset:4352
    ds_write_b16 v26, v105 offset:4608
    ds_write_b16_d16_hi v27, v105 offset:4864
    ds_write_b16 v28, v106 offset:6144
    ds_write_b16_d16_hi v29, v106 offset:6400
    ds_write_b16 v30, v107 offset:6656
    ds_write_b16_d16_hi v31, v107 offset:6912
    ds_read_b128 v[84:87], v21
    ds_read_b128 v[88:91], v21 offset:4096
    s_waitcnt lgkmcnt(1)
    buffer_store_dwordx4 v[84:87], v22, s[24:27], 0 offen
    s_waitcnt lgkmcnt(0)
    buffer_store_dwordx4 v[88:91], v23, s[24:27], 0 offen
F_END:
    s_endpgm
POLL_P:
    ds_read_b32 v166, v7 offset:96
    s_waitcnt lgkmcnt(0)
    v_readfirstlane_b32 s62, v166
    s_cmp_gt_u32 s62, s60
    s_cbranch_scc1 POLLED_P
    s_sleep 1
    s_branch POLL_P
NOG_0:
    s_waitcnt vmcnt(0)
    s_branch NOGD_0
POLL_0:
    ds_read_b32 v166, v7 offset:96
    s_waitcnt lgkmcnt(0)
    v_readfirstlane_b32 s62, v166
    s_cmp_gt_u32 s62, s60
    s_cbranch_scc1 POLLED_0
    s_sleep 1
    s_branch POLL_0
SKIP_0:
    s_add_u32 s60, s60, 1
    s_cmp_le_u32 s62, s60
    s_cbranch_scc1 POLL_S0
POLLED_S0:
    ds_read_b32 v16, v1 offset:384
    ds_read_b128 v[8:11], v2 offset:1024
    ds_read_b128 v[12:15], v3 offset:1024
    v_smfmac_f32_32x32x32_bf16 v[52:67], v[24:27], v[100:107], v4
    v_smfmac_f32_32x32x32_bf16 v[52:67], v[28:31], v[108:115], v4
    v_mov_b64 v[84:85], 0
    v_mov_b64 v[86:87], 0
    v_mov_b64 v[88:89], 0
    v_mov_b64 v[90:91], 0
    v_mov_b64 v[92:93], 0
    v_mov_b64 v[94:95], 0
    v_mov_b64 v[96:97], 0
    v_mov_b64 v[98:99], 0
    v_mov_b64 v[24:25], 0
    v_mov_b64 v[26:27], 0
    v_mov_b64 v[28:29], 0
    v_mov_b64 v[30:31], 0
    s_waitcnt vmcnt(0) lgkmcnt(0)
    v_mfma_f32_32x32x16_bf16 v[100:115], v[8:11], v[32:35], v[132:147]
    v_mfma_f32_32x32x16_bf16 v[100:115], v[12:15], v[40:43], v[100:115]
    s_nop 9
    s_branch NEXT_0
POLL_S0:
    ds_read_b32 v166, v7 offset:96
    s_waitcnt lgkmcnt(0)
    v_readfirstlane_b32 s62, v166
    s_cmp_gt_u32 s62, s60
    s_cbranch_scc1 POLLED_S0
    s_sleep 1
    s_branch POLL_S0
NOG_1:
    s_waitcnt vmcnt(0)
    s_branch NOGD_1
POLL_1:
    ds_read_b32 v166, v7 offset:96
    s_waitcnt lgkmcnt(0)
    v_readfirstlane_b32 s62, v166
    s_cmp_gt_u32 s62, s60
    s_cbranch_scc1 POLLED_1
    s_sleep 1
    s_branch POLL_1
SKIP_1:
    s_add_u32 s60, s60, 1
    s_mov_b64 exec, 1
    ds_inc_u32 v7, v2 offset:100
    s_mov_b64 exec, -1
    s_cmp_le_u32 s62, s60
    s_cbranch_scc1 POLL_S1
POLLED_S1:
    ds_read_b32 v16, v1 offset:512
    ds_read_b128 v[8:11], v2 offset:2048
    ds_read_b128 v[12:15], v3 offset:2048
    v_smfmac_f32_32x32x32_bf16 v[52:67], v[24:27], v[84:91], v4
    v_smfmac_f32_32x32x32_bf16 v[52:67], v[28:31], v[92:99], v4
    v_mov_b64 v[100:101], 0
    v_mov_b64 v[102:103], 0
    v_mov_b64 v[104:105], 0
    v_mov_b64 v[106:107], 0
    v_mov_b64 v[108:109], 0
    v_mov_b64 v[110:111], 0
    v_mov_b64 v[112:113], 0
    v_mov_b64 v[114:115], 0
    v_mov_b64 v[24:25], 0
    v_mov_b64 v[26:27], 0
    v_mov_b64 v[28:29], 0
    v_mov_b64 v[30:31], 0
    s_waitcnt vmcnt(0) lgkmcnt(0)
    v_mfma_f32_32x32x16_bf16 v[84:99], v[8:11], v[32:35], v[148:163]
    v_mfma_f32_32x32x16_bf16 v[84:99], v[12:15], v[36:39], v[84:99]
    s_nop 9
    s_branch NEXT_1
POLL_S1:
    ds_read_b32 v166, v7 offset:96
    s_waitcnt lgkmcnt(0)
    v_readfirstlane_b32 s62, v166
    s_cmp_gt_u32 s62, s60
    s_cbranch_scc1 POLLED_S1
    s_sleep 1
    s_branch POLL_S1
NOG_2:
    s_waitcnt vmcnt(0)
    s_branch NOGD_2
POLL_2:
    ds_read_b32 v166, v7 offset:96
    s_waitcnt lgkmcnt(0)
    v_readfirstlane_b32 s62, v166
    s_cmp_gt_u32 s62, s60
    s_cbranch_scc1 POLLED_2
    s_sleep 1
    s_branch POLL_2
SKIP_2:
    s_add_u32 s60, s60, 1
    s_cmp_le_u32 s62, s60
    s_cbranch_scc1 POLL_S2
POLLED_S2:
    ds_read_b32 v16, v1 offset:640
    ds_read_b128 v[8:11], v2 offset:3072
    ds_read_b128 v[12:15], v3 offset:3072
    v_smfmac_f32_32x32x32_bf16 v[52:67], v[24:27], v[100:107], v4
    v_smfmac_f32_32x32x32_bf16 v[52:67], v[28:31], v[108:115], v4
    v_mov_b64 v[84:85], 0
    v_mov_b64 v[86:87], 0
    v_mov_b64 v[88:89], 0
    v_mov_b64 v[90:91], 0
    v_mov_b64 v[92:93], 0
    v_mov_b64 v[94:95], 0
    v_mov_b64 v[96:97], 0
    v_mov_b64 v[98:99], 0
    v_mov_b64 v[24:25], 0
    v_mov_b64 v[26:27], 0
    v_mov_b64 v[28:29], 0
    v_mov_b64 v[30:31], 0
    s_waitcnt vmcnt(0) lgkmcnt(0)
    v_mfma_f32_32x32x16_bf16 v[100:115], v[8:11], v[32:35], v[116:131]
    v_mfma_f32_32x32x16_bf16 v[100:115], v[12:15], v[40:43], v[100:115]
    s_nop 9
    s_branch NEXT_2
POLL_S2:
    ds_read_b32 v166, v7 offset:96
    s_waitcnt lgkmcnt(0)
    v_readfirstlane_b32 s62, v166
    s_cmp_gt_u32 s62, s60
    s_cbranch_scc1 POLLED_S2
    s_sleep 1
    s_branch POLL_S2
NOG_3:
    s_waitcnt vmcnt(0)
    s_branch NOGD_3
POLL_3:
    ds_read_b32 v166, v7 offset:96
    s_waitcnt lgkmcnt(0)
    v_readfirstlane_b32 s62, v166
    s_cmp_gt_u32 s62, s60
    s_cbranch_scc1 POLLED_3
    s_sleep 1
    s_branch POLL_3
SKIP_3:
    s_add_u32 s60, s60, 1
    s_mov_b64 exec, 1
    ds_inc_u32 v7, v2 offset:100
    s_mov_b64 exec, -1
    s_cmp_le_u32 s62, s60
    s_cbranch_scc1 POLL_S3
POLLED_S3:
    ds_read_b32 v16, v1 offset:768
    ds_read_b128 v[8:11], v2 offset:4096
    ds_read_b128 v[12:15], v3 offset:4096
    v_smfmac_f32_32x32x32_bf16 v[52:67], v[24:27], v[84:91], v4
    v_smfmac_f32_32x32x32_bf16 v[52:67], v[28:31], v[92:99], v4
    v_mov_b64 v[100:101], 0
    v_mov_b64 v[102:103], 0
    v_mov_b64 v[104:105], 0
    v_mov_b64 v[106:107], 0
    v_mov_b64 v[108:109], 0
    v_mov_b64 v[110:111], 0
    v_mov_b64 v[112:113], 0
    v_mov_b64 v[114:115], 0
    v_mov_b64 v[24:25], 0
    v_mov_b64 v[26:27], 0
    v_mov_b64 v[28:29], 0
    v_mov_b64 v[30:31], 0
    s_waitcnt vmcnt(0) lgkmcnt(0)
    v_mfma_f32_32x32x16_bf16 v[84:99], v[8:11], v[32:35], v[132:147]
    v_mfma_f32_32x32x16_bf16 v[84:99], v[12:15], v[36:39], v[84:99]
    s_nop 9
    s_branch NEXT_3
POLL_S3:
    ds_read_b32 v166, v7 offset:96
    s_waitcnt lgkmcnt(0)
    v_readfirstlane_b32 s62, v166
    s_cmp_gt_u32 s62, s60
    s_cbranch_scc1 POLLED_S3
    s_sleep 1
    s_branch POLL_S3
NOG_4:
    s_waitcnt vmcnt(0)
    s_branch NOGD_4
POLL_4:
    ds_read_b32 v166, v7 offset:96
    s_waitcnt lgkmcnt(0)
    v_readfirstlane_b32 s62, v166
    s_cmp_gt_u32 s62, s60
    s_cbranch_scc1 POLLED_4
    s_sleep 1
    s_branch POLL_4
SKIP_4:
    s_add_u32 s60, s60, 1
    s_cmp_le_u32 s62, s60
    s_cbranch_scc1 POLL_S4
POLLED_S4:
    ds_read_b32 v16, v1 offset:896
    ds_read_b128 v[8:11], v2 offset:5120
    ds_read_b128 v[12:15], v3 offset:5120
    v_smfmac_f32_32x32x32_bf16 v[52:67], v[24:27], v[100:107], v4
    v_smfmac_f32_32x32x32_bf16 v[52:67], v[28:31], v[108:115], v4
    v_mov_b64 v[84:85], 0
    v_mov_b64 v[86:87], 0
    v_mov_b64 v[88:89], 0
    v_mov_b64 v[90:91], 0
    v_mov_b64 v[92:93], 0
    v_mov_b64 v[94:95], 0
    v_mov_b64 v[96:97], 0
    v_mov_b64 v[98:99], 0
    v_mov_b64 v[24:25], 0
    v_mov_b64 v[26:27], 0
    v_mov_b64 v[28:29], 0
    v_mov_b64 v[30:31], 0
    s_waitcnt vmcnt(0) lgkmcnt(0)
    v_mfma_f32_32x32x16_bf16 v[100:115], v[8:11], v[32:35], v[148:163]
    v_mfma_f32_32x32x16_bf16 v[100:115], v[12:15], v[40:43], v[100:115]
    s_nop 9
    s_branch NEXT_4
POLL_S4:
    ds_read_b32 v166, v7 offset:96
    s_waitcnt lgkmcnt(0)
    v_readfirstlane_b32 s62, v166
    s_cmp_gt_u32 s62, s60
    s_cbranch_scc1 POLLED_S4
    s_sleep 1
    s_branch POLL_S4
NOG_5:
    s_waitcnt vmcnt(0)
    s_branch NOGD_5
POLL_5:
    ds_read_b32 v166, v7 offset:96
    s_waitcnt lgkmcnt(0)
    v_readfirstlane_b32 s62, v166
    s_cmp_gt_u32 s62, s60
    s_cbranch_scc1 POLLED_5
    s_sleep 1
    s_branch POLL_5
SKIP_5:
    s_add_u32 s60, s60, 1
    s_mov_b64 exec, 1
    ds_inc_u32 v7, v2 offset:100
    s_mov_b64 exec, -1
    s_cmp_le_u32 s62, s60
    s_cbranch_scc1 POLL_S5
POLLED_S5:
    ds_read_b32 v16, v1 offset:1024
    ds_read_b128 v[8:11], v2 offset:6144
    ds_read_b128 v[12:15], v3 offset:6144
    v_smfmac_f32_32x32x32_bf16 v[52:67], v[24:27], v[84:91], v4
    v_smfmac_f32_32x32x32_bf16 v[52:67], v[28:31], v[92:99], v4
    v_mov_b64 v[100:101], 0
    v_mov_b64 v[102:103], 0
    v_mov_b64 v[104:105], 0
    v_mov_b64 v[106:107], 0
    v_mov_b64 v[108:109], 0
    v_mov_b64 v[110:111], 0
    v_mov_b64 v[112:113], 0
    v_mov_b64 v[114:115], 0
    v_mov_b64 v[24:25], 0
    v_mov_b64 v[26:27], 0
    v_mov_b64 v[28:29], 0
    v_mov_b64 v[30:31], 0
    s_waitcnt vmcnt(0) lgkmcnt(0)
    v_mfma_f32_32x32x16_bf16 v[84:99], v[8:11], v[32:35], v[116:131]
    v_mfma_f32_32x32x16_bf16 v[84:99], v[12:15], v[36:39], v[84:99]
    s_nop 9
    s_branch NEXT_5
POLL_S5:
    ds_read_b32 v166, v7 offset:96
    s_waitcnt lgkmcnt(0)
    v_readfirstlane_b32 s62, v166
    s_cmp_gt_u32 s62, s60
    s_cbranch_scc1 POLLED_S5
    s_sleep 1
    s_branch POLL_S5
SLOWNEXT:
    s_cmp_eq_u32 s55, 999
    s_cbranch_scc1 EPI
    s_add_u32 s55, s55, 1
OVF:
    s_mov_b32 s54, 1
    s_waitcnt vmcnt(0) lgkmcnt(0)
    s_barrier
    s_branch ROUND
SLOWSRC:
    s_mul_i32 s76, s55, 1600
    v_lshlrev_b32 v136, 2, v0
    buffer_load_dword v135, v136, s[44:47], s76 offen
    buffer_load_dword v132, v136, s[40:43], s76 offen
    s_mul_i32 s78, s55, 12800
    v_lshl_add_u32 v148, v0, 5, 1
    v_mov_b32 v134, s78
    s_waitcnt vmcnt(0) lgkmcnt(0)
    s_barrier
    v_lshl_or_b32 v148, v132, 18, v148
    v_lshrrev_b32 v149, 10, v135
    v_add_u32 v116, v149, v148
    v_and_b32 v149, 255, v135
    v_cmp_eq_u32 vcc, s2, v149
    v_lshrrev_b32 v132, 7, v132
    v_and_b32 v132, 24, v132
    v_cndmask_b32_e64 v133, 0, 1, vcc
    v_cmp_gt_u32 vcc, 400, v0
    v_bfe_u32 v135, v135, 8, 2
    v_lshlrev_b32 v133, v132, v133
    v_lshlrev_b32 v135, 3, v135
    v_cndmask_b32 v133, 0, v133, vcc
    s_branch ALLOC
HELP:
PROUND:
    v_and_b32 v15, 3, v1
    v_lshlrev_b32 v15, 3, v15
    v_lshrrev_b32 v2, 1, v1
    v_lshlrev_b32 v2, 2, v2
    v_and_b32 v3, 1, v1
    v_lshlrev_b32 v3, 4, v3
    v_mov_b32 v5, 1
    v_and_b32 v10, 7, v1
    v_bfe_u32 v11, v1, 3, 1
    v_lshlrev_b32 v10, 1, v10
    v_lshl_add_u32 v10, v11, 9, v10
    v_lshl_add_u32 v10, v1, 4, v10
    v_mov_b32 v11, 0x3f80
    s_barrier
    s_mov_b64 exec, 0x1fff
    ds_write_b16 v10, v11 offset:272
    s_mov_b64 exec, -1
    s_cmp_lg_u32 s3, 8
    s_cbranch_scc1 H_G2
    s_cmp_lg_u32 s54, 0
    s_cbranch_scc1 H_G2
    v_lshlrev_b32 v14, 7, v1
    s_lshl_b32 s76, s57, 13
    v_add_u32 v14, s76, v14
    s_mov_b32 s81, 0
WAITF2:
    buffer_load_dwordx4 v[40:43], v32, s[16:19], 0 offen sc1
    s_waitcnt vmcnt(0)
    v_and_b32 v40, v40, v41
    v_and_b32 v42, v42, v43
    v_and_b32 v40, v40, v42
    v_cmpx_ne_u32 vcc, 1, v40
    s_cbranch_execz ALLIN2
    s_sleep 2
    s_add_u32 s81, s81, 1
    s_cmp_lt_u32 s81, 0x100000
    s_cbranch_scc1 WAITF2
ALLIN2:
    s_mov_b64 exec, -1
H_G2:
    s_sleep 8
WA_H:
    ds_read_b32 v8, v7 offset:104
    s_waitcnt lgkmcnt(0)
    v_readfirstlane_b32 s80, v8
    s_cmp_lt_u32 s80, 8
    s_cbranch_scc1 WA_H
    ds_read_b64 v[8:9], v15 offset:64
    s_waitcnt lgkmcnt(0)
    v_add_u32 v8, v8, v9
    v_add_u32_sdwa v8, v8, v8 dst_sel:DWORD dst_unused:UNUSED_PAD src0_sel:WORD_0 src1_sel:WORD_1
    v_add_u32 v8, 31, v8
    v_lshrrev_b32 v8, 4, v8
    v_and_b32 v8, -2, v8
    s_nop 0
    v_readlane_b32 s68, v8, 0
    v_readlane_b32 s69, v8, 1
    v_readlane_b32 s70, v8, 2
    v_readlane_b32 s71, v8, 3
    s_sub_i32 s72, s68, 1
    s_sub_i32 s73, s70, 1
    s_max_i32 s72, s72, s69
    s_max_i32 s73, s73, s71
    s_add_u32 s74, s72, s73
    s_cmp_gt_u32 s74, 62
    s_cbranch_scc1 POVF
    s_cmp_lg_u32 s3, 8
    s_cbranch_scc1 EXP
    s_max_u32 s61, s72, s73
    s_lshl_b32 s78, s72, 7
    v_add_u32 v6, s78, v2
    s_mov_b32 s60, 0
    s_mov_b32 s76, 81920
    s_mov_b32 s79, -20
    s_mov_b32 s62, 0
    s_lshl_b32 s77, s72, 10
    s_add_u32 s77, s77, 81920
    s_mov_b32 s82, -32
    s_mov_b32 s83, 0
    s_barrier
    ds_read_b32 v10, v2 offset:9216
    ds_read_b32 v11, v6 offset:9216
PSTEP:
    s_cmp_ge_u32 s60, s61
    s_cbranch_scc1 PDRAIN
    s_cmp_lt_i32 s62, s79
    s_cbranch_scc1 PW
PWD:
    s_min_u32 m0, s76, 146432
    s_waitcnt lgkmcnt(0)
    v_and_or_b32 v12, v10, s82, v3
    v_and_or_b32 v13, v11, s82, v3
    v_add_u32 v2, 128, v2
    v_add_u32 v6, 128, v6
    buffer_load_dwordx4 v12, s[12:15], 0 offen lds
    s_min_u32 m0, s77, 146432
    ds_read_b32 v10, v2 offset:9216
    buffer_load_dwordx4 v13, s[12:15], 0 offen lds
    ds_read_b32 v11, v6 offset:9216
    s_add_u32 s76, s76, 1024
    s_add_u32 s77, s77, 1024
    s_add_i32 s79, s79, 4
    s_add_u32 s60, s60, 1
    s_cmp_le_u32 s60, 1
    s_cbranch_scc1 PSTEP
    s_cmp_lt_u32 s83, s60
    s_cbranch_scc1 PO
POD:
    s_mov_b64 exec, 1
    s_waitcnt vmcnt(2)
    ds_add_u32 v7, v5 offset:96
    s_mov_b64 exec, -1
    s_branch PSTEP
PW:
    ds_read_b32 v8, v7 offset:100
    s_waitcnt lgkmcnt(0)
    v_readfirstlane_b32 s62, v8
    s_cmp_ge_i32 s62, s79
    s_cbranch_scc1 PWD
    s_sleep 2
    s_branch PW
PO:
    ds_read_b32 v8, v7 offset:108
    s_waitcnt lgkmcnt(0)
    v_readfirstlane_b32 s83, v8
    s_and_b32 s80, s83, 3
    s_cmp_eq_u32 s80, 3
    s_cselect_b32 s80, 4, 0
    s_cmp_eq_u32 s83, 15
    s_cselect_b32 s83, -1, s80
    s_cmp_ge_u32 s83, s60
    s_cbranch_scc1 POD
    s_sleep 1
    s_branch PO
EXP:
    s_sub_u32 s60, s3, 9
    s_add_u32 s77, s60, s72
    s_min_u32 s77, s77, 62
    s_lshl_b32 s76, s60, 7
    v_add_u32 v10, s76, v2
    s_lshl_b32 s76, s77, 7
    v_add_u32 v11, s76, v2
    s_lshl_b32 s76, s60, 10
    v_lshl_add_u32 v12, v1, 4, s76
    s_lshl_b32 s76, s77, 10
    v_lshl_add_u32 v13, v1, 4, s76
    v_mov_b32 v14, 4
    s_mul_i32 s76, s60, 2688
    s_add_u32 s76, s76, 9216
    v_add_u32 v2, s76, v2
    s_mul_i32 s76, s60, 21504
    s_add_u32 s76, s76, 17408
    v_lshl_add_u32 v6, v1, 4, s76
    v_lshlrev_b32 v3, 5, v3
    s_setprio 3
    s_barrier
    ds_read_b32 v10, v10 offset:9216
    ds_read_b32 v11, v11 offset:9216
    s_waitcnt lgkmcnt(1)
    v_and_b32 v10, 31, v10
    v_lshl_add_u32 v10, v10, 4, v3
    ds_read_b128 v[128:131], v10 offset:256
    s_waitcnt lgkmcnt(1)
    v_and_b32 v11, 31, v11
    v_lshl_add_u32 v11, v11, 4, v3
    ds_read_b128 v[132:135], v11 offset:256
    s_waitcnt lgkmcnt(1)
    ds_write_b128 v12, v[128:131] offset:17408
    s_waitcnt lgkmcnt(1)
    ds_write_b128 v13, v[132:135] offset:17408
    s_mov_b64 exec, 1
    ds_add_u32 v7, v5 offset:108
    s_mov_b64 exec, -1
    s_setprio 3
    ds_read2_b32 v[16:17], v2 offset0:0 offset1:32
    ds_read2_b32 v[18:19], v2 offset0:64 offset1:96
    ds_read2_b32 v[20:21], v2 offset0:128 offset1:160
    ds_read2_b32 v[22:23], v2 offset0:192 offset1:224
    v_add_u32 v2, 1024, v2
    ds_read2_b32 v[24:25], v2 offset0:0 offset1:32
    ds_read2_b32 v[26:27], v2 offset0:64 offset1:96
    ds_read2_b32 v[28:29], v2 offset0:128 offset1:160
    ds_read2_b32 v[30:31], v2 offset0:192 offset1:224
    v_add_u32 v2, 1024, v2
    ds_read2_b32 v[32:33], v2 offset0:0 offset1:32
    ds_read2_b32 v[34:35], v2 offset0:64 offset1:96
    ds_read2_b32 v[36:37], v2 offset0:128 offset1:160
    s_waitcnt lgkmcnt(10)
    v_and_b32 v16, 31, v16
    v_lshl_add_u32 v16, v16, 4, v3
    ds_read_b128 v[40:43], v16 offset:256
    v_and_b32 v17, 31, v17
    v_lshl_add_u32 v17, v17, 4, v3
    ds_read_b128 v[44:47], v17 offset:256
    s_waitcnt lgkmcnt(11)
    v_and_b32 v18, 31, v18
    v_lshl_add_u32 v18, v18, 4, v3
    ds_read_b128 v[48:51], v18 offset:256
    v_and_b32 v19, 31, v19
    v_lshl_add_u32 v19, v19, 4, v3
    ds_read_b128 v[52:55], v19 offset:256
    s_waitcnt lgkmcnt(12)
    v_and_b32 v20, 31, v20
    v_lshl_add_u32 v20, v20, 4, v3
    ds_read_b128 v[56:59], v20 offset:256
    v_and_b32 v21, 31, v21
    v_lshl_add_u32 v21, v21, 4, v3
    ds_read_b128 v[60:63], v21 offset:256
    s_waitcnt lgkmcnt(5)
    ds_write_b128 v6, v[40:43] offset:0
    s_waitcnt lgkmcnt(14)
    v_and_b32 v22, 31, v22
    v_lshl_add_u32 v22, v22, 4, v3
    ds_read_b128 v[64:67], v22 offset:256
    s_waitcnt lgkmcnt(6)
    ds_write_b128 v6, v[44:47] offset:1024
    v_and_b32 v23, 31, v23
    v_lshl_add_u32 v23, v23, 4, v3
    ds_read_b128 v[68:71], v23 offset:256
    s_waitcnt lgkmcnt(7)
    ds_write_b128 v6, v[48:51] offset:2048
    s_waitcnt lgkmcnt(15)
    v_and_b32 v24, 31, v24
    v_lshl_add_u32 v24, v24, 4, v3
    ds_read_b128 v[72:75], v24 offset:256
    s_waitcnt lgkmcnt(8)
    ds_write_b128 v6, v[52:55] offset:3072
    v_and_b32 v25, 31, v25
    v_lshl_add_u32 v25, v25, 4, v3
    ds_read_b128 v[76:79], v25 offset:256
    s_waitcnt lgkmcnt(9)
    ds_write_b128 v6, v[56:59] offset:4096
    s_waitcnt lgkmcnt(15)
    v_and_b32 v26, 31, v26
    v_lshl_add_u32 v26, v26, 4, v3
    ds_read_b128 v[80:83], v26 offset:256
    s_waitcnt lgkmcnt(10)
    ds_write_b128 v6, v[60:63] offset:5120
    v_and_b32 v27, 31, v27
    v_lshl_add_u32 v27, v27, 4, v3
    ds_read_b128 v[84:87], v27 offset:256
    s_waitcnt lgkmcnt(10)
    ds_write_b128 v6, v[64:67] offset:6144
    s_waitcnt lgkmcnt(15)
    v_and_b32 v28, 31, v28
    v_lshl_add_u32 v28, v28, 4, v3
    ds_read_b128 v[88:91], v28 offset:256
    s_waitcnt lgkmcnt(10)
    ds_write_b128 v6, v[68:71] offset:7168
    v_and_b32 v29, 31, v29
    v_lshl_add_u32 v29, v29, 4, v3
    ds_read_b128 v[92:95], v29 offset:256
    s_waitcnt lgkmcnt(10)
    ds_write_b128 v6, v[72:75] offset:8192
    s_waitcnt lgkmcnt(15)
    v_and_b32 v30, 31, v30
    v_lshl_add_u32 v30, v30, 4, v3
    ds_read_b128 v[96:99], v30 offset:256
    s_waitcnt lgkmcnt(10)
    ds_write_b128 v6, v[76:79] offset:9216
    v_and_b32 v31, 31, v31
    v_lshl_add_u32 v31, v31, 4, v3
    ds_read_b128 v[100:103], v31 offset:256
    s_waitcnt lgkmcnt(10)
    ds_write_b128 v6, v[80:83] offset:10240
    s_waitcnt lgkmcnt(15)
    v_and_b32 v32, 31, v32
    v_lshl_add_u32 v32, v32, 4, v3
    ds_read_b128 v[104:107], v32 offset:256
    s_waitcnt lgkmcnt(10)
    ds_write_b128 v6, v[84:87] offset:11264
    v_and_b32 v33, 31, v33
    v_lshl_add_u32 v33, v33, 4, v3
    ds_read_b128 v[108:111], v33 offset:256
    s_waitcnt lgkmcnt(10)
    ds_write_b128 v6, v[88:91] offset:12288
    s_waitcnt lgkmcnt(15)
    v_and_b32 v34, 31, v34
    v_lshl_add_u32 v34, v34, 4, v3
    ds_read_b128 v[112:115], v34 offset:256
    s_waitcnt lgkmcnt(10)
    ds_write_b128 v6, v[92:95] offset:13312
    v_and_b32 v35, 31, v35
    v_lshl_add_u32 v35, v35, 4, v3
    ds_read_b128 v[116:119], v35 offset:256
    s_waitcnt lgkmcnt(10)
    ds_write_b128 v6, v[96:99] offset:14336
    s_waitcnt lgkmcnt(15)
    v_and_b32 v36, 31, v36
    v_lshl_add_u32 v36, v36, 4, v3
    ds_read_b128 v[120:123], v36 offset:256
    s_waitcnt lgkmcnt(10)
    ds_write_b128 v6, v[100:103] offset:15360
    s_waitcnt lgkmcnt(9)
    ds_write_b128 v6, v[104:107] offset:16384
    s_waitcnt lgkmcnt(8)
    ds_write_b128 v6, v[108:111] offset:17408
    s_waitcnt lgkmcnt(7)
    ds_write_b128 v6, v[112:115] offset:18432
    s_waitcnt lgkmcnt(6)
    ds_write_b128 v6, v[116:119] offset:19456
    s_waitcnt lgkmcnt(5)
    ds_write_b128 v6, v[120:123] offset:20480
EDONE:
    s_mov_b64 exec, 1
    ds_add_u32 v7, v14 offset:108
    s_mov_b64 exec, -1
    s_branch PFIN
PDRAIN:
    ds_read_b32 v8, v7 offset:108
    s_waitcnt lgkmcnt(0)
    v_readfirstlane_b32 s83, v8
    s_cmp_lt_u32 s83, 15
    s_cbranch_scc1 PDRAIN
    s_mov_b64 exec, 1
    v_mov_b32 v5, 0x7fffffff
    s_waitcnt vmcnt(0)
    ds_write_b32 v7, v5 offset:96
    s_mov_b64 exec, -1
PFIN:
    s_cmp_eq_u32 s54, 0
    s_cbranch_scc1 PEND
    s_cmp_eq_u32 s55, 999
    s_cbranch_scc1 PEND
    s_add_u32 s55, s55, 1
POVF:
    s_mov_b32 s54, 1
    s_waitcnt vmcnt(0) lgkmcnt(0)
    s_barrier
    s_branch PROUND
PEND:
    s_endpgm
CODE_END:
.section .rodata,"a"
.p2align 6
.amdhsa_kernel standalone__edge_featured_mpnn_gatedgcn__graph_kernel
  .amdhsa_next_free_vgpr 168
  .amdhsa_next_free_sgpr 102
  .amdhsa_accum_offset 168
  .amdhsa_group_segment_fixed_size 0
  .amdhsa_kernarg_size 96
  .amdhsa_user_sgpr_count 2
  .amdhsa_user_sgpr_kernarg_segment_ptr 1
  .amdhsa_system_sgpr_workgroup_id_x 1
.end_amdhsa_kernel
```
